```python
import torch

def _softmax(x, axis=-1):
    return torch.softmax(x, dim=axis)
def _gelu(x):
    return torch.nn.functional.gelu(x, approximate="tanh")
def _silu(x):
    return torch.nn.functional.silu(x)
def _sigmoid(x):
    return torch.sigmoid(x)
def _layernorm(x, axis=-1, eps=1e-5):
    m = x.mean(dim=axis, keepdim=True)
    v = x.var(dim=axis, keepdim=True, unbiased=False)
    return (x - m) / torch.sqrt(v + eps)
def _scatter_add(tgt, idx, src, axis=0):
    return tgt.clone().index_add_(axis, idx, src)
def _segment_sum(src, seg, n):
    out = torch.zeros((n,) + src.shape[1:], dtype=src.dtype)
    return out.index_add_(0, seg, src)
def _pad(x, pw):
    flat = tuple(v for pair in reversed(pw) for v in pair)
    return torch.nn.functional.pad(x, flat)

kernel_name = 'sequential_preLN__softmax_full_mha__mixer_token_mlp__prompt'

def setup_inputs():

    _w = (lambda a: (lambda t: t.to(torch.bfloat16) if t.is_floating_point() else t)(torch.as_tensor(a)))
    def _A_setup():
        B, S, D = 1, 2048, 576
        return {
            "x": _w((lambda *s: torch.randn(*s, dtype=torch.bfloat16) * 0.05)(B, S, D)),
            "wqkv": _w((lambda *s: torch.randn(*s, dtype=torch.bfloat16) * 0.05)(D, 3 * D)),
            "wo": _w((lambda *s: torch.randn(*s, dtype=torch.bfloat16) * 0.05)(D, D)),
        }
    _A_in = _A_setup()

    def _B_setup():
        B, S, D, F = 1, 2048, 576, 4608
        return {
            "x": _w((lambda *s: torch.randn(*s, dtype=torch.bfloat16) * 0.05)(B, S, D)),
            "w1": _w((lambda *s: torch.randn(*s, dtype=torch.bfloat16) * 0.8)(S, F) * (S ** -0.5)),
            "b1": _w((lambda *s: torch.randn(*s, dtype=torch.bfloat16) * 12.8)(F) * 0.02),
            "w2": _w((lambda *s: torch.randn(*s, dtype=torch.bfloat16) * 0.4)(F, S) * (F ** -0.5)),
            "b2": _w((lambda *s: torch.randn(*s, dtype=torch.bfloat16) * 6.4)(S) * 0.02),
        }
    _B_in = _B_setup()

    return {
        "A_x": _A_in["x"],
        "A_wqkv": _A_in["wqkv"],
        "A_wo": _A_in["wo"],
        "B_x": _B_in["x"],
        "B_w1": _B_in["w1"],
        "B_b1": _B_in["b1"],
        "B_w2": _B_in["w2"],
        "B_b2": _B_in["b2"],
    }

def reference(A_x, A_wqkv, A_wo, B_x, B_w1, B_b1, B_w2, B_b2):
    def _A_ref(x, wqkv, wo):
        B, S, D = x.shape
        H = 32; Dh = D // H
        qkv = (lambda x, *d: x.permute(*d))((x @ wqkv).reshape(B, S, 3, H, Dh), 2, 0, 3, 1, 4)
        q, k, v = qkv[0], qkv[1], qkv[2]
        scale = Dh ** -0.5
        scores = torch.einsum("bhqd,bhkd->bhqk", q, k) * scale
        p = _softmax(scores, axis=-1)
        o = torch.einsum("bhqk,bhkd->bhqd", p, v)
        return (lambda x, *d: x.permute(*d))(o, 0, 2, 1, 3).reshape(B, S, D) @ wo

    def _B_ref(x, w1, b1, w2, b2):
        B, S, D = x.shape
        h = _layernorm(x, axis=-1)
        u = torch.einsum("bsd,sf->bdf", h, w1) + b1
        u = _gelu(u)
        y = torch.einsum("bdf,fs->bds", u, w2) + b2
        return (lambda x, *d: x.permute(*d))(y, 0, 2, 1)

    x = A_x
    h = x + _A_ref(_layernorm(x, axis=-1), A_wqkv, A_wo)
    h2 = h + _B_ref(_layernorm(h, axis=-1), B_w1, B_b1, B_w2, B_b2)
    return h2
```

```asm
; @launch kernel=qkv_kernel grid=(192,1,1) block=(512,1,1) lds=139264
; @launch kernel=attn_kernel grid=(256,1,1) block=(768,1,1) lds=163840
; @launch kernel=oproj_kernel grid=(192,1,1) block=(512,1,1) lds=123904
; @launch kernel=ln_kernel grid=(576,1,1) block=(256,1,1) lds=0
; @launch kernel=mlp1_kernel grid=(216,1,1) block=(512,1,1) lds=143360
; @launch kernel=mlp2_kernel grid=(256,1,1) block=(512,1,1) lds=139264
; @launch kernel=final_kernel grid=(576,1,1) block=(256,1,1) lds=0
.amdgcn_target "amdgcn-amd-amdhsa--gfx950"
.text
.globl qkv_kernel
.p2align 8
.type qkv_kernel,@function
qkv_kernel:
    s_cmp_ge_u32 s2, 192
    s_cbranch_scc1 qkv_kernel_end
    s_load_dwordx2 s[4:5], s[0:1], 0
    s_load_dwordx2 s[6:7], s[0:1], 8
    s_load_dwordx2 s[28:29], s[0:1], 80
    s_load_dwordx2 s[64:65], s[0:1], 32
    v_and_b32 v1, 63, v0
    v_lshrrev_b32 v2, 4, v1
    v_and_b32 v3, 15, v1
    v_lshrrev_b32 v4, 6, v0
    s_nop 1
    v_readfirstlane_b32 s26, v4
    s_and_b32 s52, s2, 7
    s_lshr_b32 s53, s2, 3
    s_mul_i32 s30, s52, 24
    s_add_u32 s30, s30, s53
    s_mul_i32 s24, s30, 5462
    s_lshr_b32 s24, s24, 16
    s_mul_i32 s25, s24, 12
    s_sub_u32 s25, s30, s25
    s_lshr_b32 s41, s25, 2
    s_waitcnt lgkmcnt(0)
    s_mov_b32 s8, s4
    s_mov_b32 s9, s5
    s_mov_b32 s10, 2359296
    s_mov_b32 s11, 0x00020000
    s_mov_b32 s12, s6
    s_mov_b32 s13, s7
    s_mov_b32 s14, 1990656
    s_mov_b32 s15, 0x00020000
    s_add_u32 s16, s28, 0
    s_addc_u32 s17, s29, 0
    s_mov_b32 s18, 3145728
    s_mov_b32 s19, 0x00020000
    s_add_u32 s20, s28, 3145728
    s_addc_u32 s21, s29, 0
    s_mov_b32 s22, 5120000
    s_mov_b32 s23, 0x00020000
    s_mov_b32 s68, s64
    s_mov_b32 s69, s65
    s_mov_b32 s70, 18874368
    s_mov_b32 s71, 0x00020000
    s_cmp_ge_u32 s2, 192
    s_cbranch_scc0 qkv_kernel_work
    s_sub_u32 s54, s53, 24
    s_lshl_b32 s54, s54, 3
    s_add_u32 s54, s54, s26
    s_mul_i32 s54, s54, 96
    s_mul_i32 s57, s52, 1152
    s_mov_b32 exec_hi, 0xffff
    s_endpgm
qkv_kernel_work:
    s_cmp_ge_u32 s26, 4
    s_cbranch_scc0 qkv_kernel_cons
    s_sub_u32 s26, s26, 4
    s_lshl_b32 s30, s26, 2
    v_add_u32 v10, s30, v2
    v_and_b32 v10, 7, v10
    v_and_b32 v11, 7, v1
    v_xor_b32 v10, v10, v11
    v_lshrrev_b32 v11, 3, v1
    s_lshl_b32 s30, s24, 7
    s_lshl_b32 s31, s26, 3
    s_add_u32 s30, s30, s31
    v_add_u32 v11, s30, v11
    v_mul_u32_u24 v11, 1152, v11
    v_lshl_add_u32 v5, v10, 4, v11
    s_lshl_b32 s32, s26, 6
    s_and_b32 s33, s26, 1
    s_add_u32 s33, s33, 16
    s_lshl_b32 s30, s33, 6
    s_mul_i32 s31, s25, 288
    v_add_u32 v20, s32, v1
    v_mul_u32_u24 v21, 3641, v20
    v_lshrrev_b32 v21, 16, v21
    v_mul_u32_u24 v22, 18, v21
    v_sub_u32 v22, v20, v22
    v_and_b32 v23, 0x33, v21
    v_and_b32 v24, 4, v21
    v_lshlrev_b32 v24, 1, v24
    v_or_b32 v23, v23, v24
    v_and_b32 v24, 8, v21
    v_lshrrev_b32 v24, 1, v24
    v_or_b32 v23, v23, v24
    v_mul_u32_u24 v23, 3456, v23
    v_lshl_add_u32 v23, v22, 4, v23
    v_add_u32 v6, s31, v23
    v_add_u32 v20, s32, v1
    v_add_u32 v20, 256, v20
    v_mul_u32_u24 v21, 3641, v20
    v_lshrrev_b32 v21, 16, v21
    v_mul_u32_u24 v22, 18, v21
    v_sub_u32 v22, v20, v22
    v_and_b32 v23, 0x33, v21
    v_and_b32 v24, 4, v21
    v_lshlrev_b32 v24, 1, v24
    v_or_b32 v23, v23, v24
    v_and_b32 v24, 8, v21
    v_lshrrev_b32 v24, 1, v24
    v_or_b32 v23, v23, v24
    v_mul_u32_u24 v23, 3456, v23
    v_lshl_add_u32 v23, v22, 4, v23
    v_add_u32 v7, s31, v23
    v_add_u32 v20, s32, v1
    v_add_u32 v20, 512, v20
    v_mul_u32_u24 v21, 3641, v20
    v_lshrrev_b32 v21, 16, v21
    v_mul_u32_u24 v22, 18, v21
    v_sub_u32 v22, v20, v22
    v_and_b32 v23, 0x33, v21
    v_and_b32 v24, 4, v21
    v_lshlrev_b32 v24, 1, v24
    v_or_b32 v23, v23, v24
    v_and_b32 v24, 8, v21
    v_lshrrev_b32 v24, 1, v24
    v_or_b32 v23, v23, v24
    v_mul_u32_u24 v23, 3456, v23
    v_lshl_add_u32 v23, v22, 4, v23
    v_add_u32 v8, s31, v23
    v_add_u32 v20, s32, v1
    v_add_u32 v20, 768, v20
    v_mul_u32_u24 v21, 3641, v20
    v_lshrrev_b32 v21, 16, v21
    v_mul_u32_u24 v22, 18, v21
    v_sub_u32 v22, v20, v22
    v_and_b32 v23, 0x33, v21
    v_and_b32 v24, 4, v21
    v_lshlrev_b32 v24, 1, v24
    v_or_b32 v23, v23, v24
    v_and_b32 v24, 8, v21
    v_lshrrev_b32 v24, 1, v24
    v_or_b32 v23, v23, v24
    v_mul_u32_u24 v23, 3456, v23
    v_lshl_add_u32 v23, v22, 4, v23
    v_add_u32 v9, s31, v23
    v_add_u32 v20, s30, v1
    v_mul_u32_u24 v21, 3641, v20
    v_lshrrev_b32 v21, 16, v21
    v_mul_u32_u24 v22, 18, v21
    v_sub_u32 v22, v20, v22
    v_and_b32 v23, 0x33, v21
    v_and_b32 v24, 4, v21
    v_lshlrev_b32 v24, 1, v24
    v_or_b32 v23, v23, v24
    v_and_b32 v24, 8, v21
    v_lshrrev_b32 v24, 1, v24
    v_or_b32 v23, v23, v24
    v_mul_u32_u24 v23, 3456, v23
    v_lshl_add_u32 v23, v22, 4, v23
    v_add_u32 v10, s31, v23
    s_lshl_b32 s46, s26, 10
    s_lshl_b32 s45, s33, 10
    s_add_u32 s45, s45, 16384
    s_mov_b32 s35, 0
    s_mov_b32 s36, 0
    s_mov_b32 s34, 0
    s_add_u32 s37, s34, s46
    s_add_u32 m0, s37, 0
    s_add_u32 s38, s35, 0
    buffer_load_dwordx4 v5, s[8:11], s38 offen lds
    s_add_u32 m0, s37, 4096
    s_add_u32 s38, s35, 36864
    buffer_load_dwordx4 v5, s[8:11], s38 offen lds
    s_add_u32 m0, s37, 8192
    s_add_u32 s38, s35, 73728
    buffer_load_dwordx4 v5, s[8:11], s38 offen lds
    s_add_u32 m0, s37, 12288
    s_add_u32 s38, s35, 110592
    buffer_load_dwordx4 v5, s[8:11], s38 offen lds
    s_add_u32 m0, s37, 16384
    s_nop 0
    buffer_load_dwordx4 v6, s[12:15], s36 offen lds
    s_add_u32 m0, s37, 20480
    s_nop 0
    buffer_load_dwordx4 v7, s[12:15], s36 offen lds
    s_add_u32 m0, s37, 24576
    s_nop 0
    buffer_load_dwordx4 v8, s[12:15], s36 offen lds
    s_add_u32 m0, s37, 28672
    s_nop 0
    buffer_load_dwordx4 v9, s[12:15], s36 offen lds
    s_add_u32 m0, s34, s45
    s_nop 0
    buffer_load_dwordx4 v10, s[12:15], s36 offen lds
    s_add_u32 s35, s35, 128
    s_add_u32 s36, s36, 221184
    s_add_u32 s34, s34, 34816
    s_cmp_eq_u32 s34, 139264
    s_cselect_b32 s34, 0, s34
    s_add_u32 s37, s34, s46
    s_add_u32 m0, s37, 0
    s_add_u32 s38, s35, 0
    buffer_load_dwordx4 v5, s[8:11], s38 offen lds
    s_add_u32 m0, s37, 4096
    s_add_u32 s38, s35, 36864
    buffer_load_dwordx4 v5, s[8:11], s38 offen lds
    s_add_u32 m0, s37, 8192
    s_add_u32 s38, s35, 73728
    buffer_load_dwordx4 v5, s[8:11], s38 offen lds
    s_add_u32 m0, s37, 12288
    s_add_u32 s38, s35, 110592
    buffer_load_dwordx4 v5, s[8:11], s38 offen lds
    s_add_u32 m0, s37, 16384
    s_nop 0
    buffer_load_dwordx4 v6, s[12:15], s36 offen lds
    s_add_u32 m0, s37, 20480
    s_nop 0
    buffer_load_dwordx4 v7, s[12:15], s36 offen lds
    s_add_u32 m0, s37, 24576
    s_nop 0
    buffer_load_dwordx4 v8, s[12:15], s36 offen lds
    s_add_u32 m0, s37, 28672
    s_nop 0
    buffer_load_dwordx4 v9, s[12:15], s36 offen lds
    s_add_u32 m0, s34, s45
    s_nop 0
    buffer_load_dwordx4 v10, s[12:15], s36 offen lds
    s_add_u32 s35, s35, 128
    s_add_u32 s36, s36, 221184
    s_add_u32 s34, s34, 34816
    s_cmp_eq_u32 s34, 139264
    s_cselect_b32 s34, 0, s34
    s_add_u32 s37, s34, s46
    s_add_u32 m0, s37, 0
    s_add_u32 s38, s35, 0
    buffer_load_dwordx4 v5, s[8:11], s38 offen lds
    s_add_u32 m0, s37, 4096
    s_add_u32 s38, s35, 36864
    buffer_load_dwordx4 v5, s[8:11], s38 offen lds
    s_add_u32 m0, s37, 8192
    s_add_u32 s38, s35, 73728
    buffer_load_dwordx4 v5, s[8:11], s38 offen lds
    s_add_u32 m0, s37, 12288
    s_add_u32 s38, s35, 110592
    buffer_load_dwordx4 v5, s[8:11], s38 offen lds
    s_add_u32 m0, s37, 16384
    s_nop 0
    buffer_load_dwordx4 v6, s[12:15], s36 offen lds
    s_add_u32 m0, s37, 20480
    s_nop 0
    buffer_load_dwordx4 v7, s[12:15], s36 offen lds
    s_add_u32 m0, s37, 24576
    s_nop 0
    buffer_load_dwordx4 v8, s[12:15], s36 offen lds
    s_add_u32 m0, s37, 28672
    s_nop 0
    buffer_load_dwordx4 v9, s[12:15], s36 offen lds
    s_add_u32 m0, s34, s45
    s_nop 0
    buffer_load_dwordx4 v10, s[12:15], s36 offen lds
    s_add_u32 s35, s35, 128
    s_add_u32 s36, s36, 221184
    s_add_u32 s34, s34, 34816
    s_cmp_eq_u32 s34, 139264
    s_cselect_b32 s34, 0, s34
    s_waitcnt vmcnt(18)
    s_barrier
    s_mov_b32 s40, 0
qkv_kernel_lloop:
    s_waitcnt vmcnt(9)
    s_barrier
    s_add_u32 s37, s34, s46
    s_add_u32 m0, s37, 0
    s_add_u32 s38, s35, 0
    buffer_load_dwordx4 v5, s[8:11], s38 offen lds
    s_add_u32 m0, s37, 4096
    s_add_u32 s38, s35, 36864
    buffer_load_dwordx4 v5, s[8:11], s38 offen lds
    s_add_u32 m0, s37, 8192
    s_add_u32 s38, s35, 73728
    buffer_load_dwordx4 v5, s[8:11], s38 offen lds
    s_add_u32 m0, s37, 12288
    s_add_u32 s38, s35, 110592
    buffer_load_dwordx4 v5, s[8:11], s38 offen lds
    s_add_u32 m0, s37, 16384
    s_nop 0
    buffer_load_dwordx4 v6, s[12:15], s36 offen lds
    s_add_u32 m0, s37, 20480
    s_nop 0
    buffer_load_dwordx4 v7, s[12:15], s36 offen lds
    s_add_u32 m0, s37, 24576
    s_nop 0
    buffer_load_dwordx4 v8, s[12:15], s36 offen lds
    s_add_u32 m0, s37, 28672
    s_nop 0
    buffer_load_dwordx4 v9, s[12:15], s36 offen lds
    s_add_u32 m0, s34, s45
    s_nop 0
    buffer_load_dwordx4 v10, s[12:15], s36 offen lds
    s_add_u32 s35, s35, 128
    s_add_u32 s36, s36, 221184
    s_add_u32 s34, s34, 34816
    s_cmp_eq_u32 s34, 139264
    s_cselect_b32 s34, 0, s34
    s_add_u32 s40, s40, 1
    s_cmp_lt_u32 s40, 6
    s_cbranch_scc1 qkv_kernel_lloop
    s_waitcnt vmcnt(9)
    s_barrier
    s_waitcnt vmcnt(0)
    s_barrier
    s_waitcnt vmcnt(0)
    s_barrier
    s_endpgm
qkv_kernel_cons:
    v_lshrrev_b32 v240, 1, v3
    v_xor_b32 v241, v2, v240
    s_lshl_b32 s30, s26, 5
    v_add_u32 v242, s30, v3
    v_lshlrev_b32 v242, 7, v242
    v_lshl_add_u32 v8, v241, 4, v242
    v_xor_b32 v241, 4, v241
    v_lshl_add_u32 v9, v241, 4, v242
    v_lshrrev_b32 v240, 1, v2
    v_and_b32 v241, 1, v2
    v_lshlrev_b32 v240, 4, v240
    v_lshl_add_u32 v240, v241, 2, v240
    v_lshrrev_b32 v241, 2, v3
    v_add_u32 v240, v240, v241
    v_mul_u32_u24 v240, 288, v240
    v_and_b32 v241, 3, v3
    v_lshl_add_u32 v10, v241, 3, v240
    v_add_u32 v10, 16384, v10
    v_mov_b32 v112, 0
    v_mov_b32 v113, 0
    v_mov_b32 v114, 0
    v_mov_b32 v115, 0
    v_mov_b32 v116, 0
    v_mov_b32 v117, 0
    v_mov_b32 v118, 0
    v_mov_b32 v119, 0
    v_mov_b32 v120, 0
    v_mov_b32 v121, 0
    v_mov_b32 v122, 0
    v_mov_b32 v123, 0
    v_mov_b32 v124, 0
    v_mov_b32 v125, 0
    v_mov_b32 v126, 0
    v_mov_b32 v127, 0
    v_mov_b32 v128, 0
    v_mov_b32 v129, 0
    v_mov_b32 v130, 0
    v_mov_b32 v131, 0
    v_mov_b32 v132, 0
    v_mov_b32 v133, 0
    v_mov_b32 v134, 0
    v_mov_b32 v135, 0
    v_mov_b32 v136, 0
    v_mov_b32 v137, 0
    v_mov_b32 v138, 0
    v_mov_b32 v139, 0
    v_mov_b32 v140, 0
    v_mov_b32 v141, 0
    v_mov_b32 v142, 0
    v_mov_b32 v143, 0
    v_mov_b32 v144, 0
    v_mov_b32 v145, 0
    v_mov_b32 v146, 0
    v_mov_b32 v147, 0
    v_mov_b32 v148, 0
    v_mov_b32 v149, 0
    v_mov_b32 v150, 0
    v_mov_b32 v151, 0
    v_mov_b32 v152, 0
    v_mov_b32 v153, 0
    v_mov_b32 v154, 0
    v_mov_b32 v155, 0
    v_mov_b32 v156, 0
    v_mov_b32 v157, 0
    v_mov_b32 v158, 0
    v_mov_b32 v159, 0
    v_mov_b32 v160, 0
    v_mov_b32 v161, 0
    v_mov_b32 v162, 0
    v_mov_b32 v163, 0
    v_mov_b32 v164, 0
    v_mov_b32 v165, 0
    v_mov_b32 v166, 0
    v_mov_b32 v167, 0
    v_mov_b32 v168, 0
    v_mov_b32 v169, 0
    v_mov_b32 v170, 0
    v_mov_b32 v171, 0
    v_mov_b32 v172, 0
    v_mov_b32 v173, 0
    v_mov_b32 v174, 0
    v_mov_b32 v175, 0
    v_mov_b32 v176, 0
    v_mov_b32 v177, 0
    v_mov_b32 v178, 0
    v_mov_b32 v179, 0
    v_mov_b32 v180, 0
    v_mov_b32 v181, 0
    v_mov_b32 v182, 0
    v_mov_b32 v183, 0
    v_mov_b32 v184, 0
    v_mov_b32 v185, 0
    v_mov_b32 v186, 0
    v_mov_b32 v187, 0
    v_mov_b32 v188, 0
    v_mov_b32 v189, 0
    v_mov_b32 v190, 0
    v_mov_b32 v191, 0
    v_mov_b32 v192, 0
    v_mov_b32 v193, 0
    v_mov_b32 v194, 0
    v_mov_b32 v195, 0
    v_mov_b32 v196, 0
    v_mov_b32 v197, 0
    v_mov_b32 v198, 0
    v_mov_b32 v199, 0
    v_mov_b32 v200, 0
    v_mov_b32 v201, 0
    v_mov_b32 v202, 0
    v_mov_b32 v203, 0
    v_mov_b32 v204, 0
    v_mov_b32 v205, 0
    v_mov_b32 v206, 0
    v_mov_b32 v207, 0
    v_mov_b32 v208, 0
    v_mov_b32 v209, 0
    v_mov_b32 v210, 0
    v_mov_b32 v211, 0
    v_mov_b32 v212, 0
    v_mov_b32 v213, 0
    v_mov_b32 v214, 0
    v_mov_b32 v215, 0
    v_mov_b32 v216, 0
    v_mov_b32 v217, 0
    v_mov_b32 v218, 0
    v_mov_b32 v219, 0
    v_mov_b32 v220, 0
    v_mov_b32 v221, 0
    v_mov_b32 v222, 0
    v_mov_b32 v223, 0
    v_mov_b32 v224, 0
    v_mov_b32 v225, 0
    v_mov_b32 v226, 0
    v_mov_b32 v227, 0
    v_mov_b32 v228, 0
    v_mov_b32 v229, 0
    v_mov_b32 v230, 0
    v_mov_b32 v231, 0
    v_mov_b32 v232, 0
    v_mov_b32 v233, 0
    v_mov_b32 v234, 0
    v_mov_b32 v235, 0
    v_mov_b32 v236, 0x3f803f80
    v_mov_b32 v237, 0x3f803f80
    v_mov_b32 v238, 0x3f803f80
    v_mov_b32 v239, 0x3f803f80
    s_mov_b32 s42, 0
    v_mov_b32 v11, v8
    v_mov_b32 v14, v8
    v_mov_b32 v12, v9
    v_mov_b32 v15, v9
    v_mov_b32 v13, v10
    v_mov_b32 v16, v10
    s_mov_b32 s39, 0
    s_mov_b32 s40, 0
    s_barrier
    s_cmp_eq_u32 s41, 2
    s_cbranch_scc1 qkv_kernel_var1
    ds_read_b128 v[24:27], v14 offset:0
    ds_read_b128 v[28:31], v14 offset:2048
    ds_read_b64_tr_b16 v[40:41], v16 offset:0
    ds_read_b64_tr_b16 v[42:43], v16 offset:2304
    ds_read_b64_tr_b16 v[44:45], v16 offset:32
    ds_read_b64_tr_b16 v[46:47], v16 offset:2336
    ds_read_b64_tr_b16 v[48:49], v16 offset:64
    ds_read_b64_tr_b16 v[50:51], v16 offset:2368
    ds_read_b64_tr_b16 v[52:53], v16 offset:96
    ds_read_b64_tr_b16 v[54:55], v16 offset:2400
    ds_read_b64_tr_b16 v[56:57], v16 offset:128
    ds_read_b64_tr_b16 v[58:59], v16 offset:2432
    ds_read_b64_tr_b16 v[60:61], v16 offset:160
    ds_read_b64_tr_b16 v[62:63], v16 offset:2464
    ds_read_b64_tr_b16 v[64:65], v16 offset:192
    ds_read_b64_tr_b16 v[66:67], v16 offset:2496
    ds_read_b64_tr_b16 v[68:69], v16 offset:224
    ds_read_b64_tr_b16 v[70:71], v16 offset:2528
    ds_read_b64_tr_b16 v[72:73], v16 offset:256
    ds_read_b64_tr_b16 v[74:75], v16 offset:2560
qkv_kernel_loop0:
    s_add_u32 s39, s39, 34816
    s_cmp_eq_u32 s39, 139264
    s_cselect_b32 s39, 0, s39
    v_mov_b32 v11, v14
    v_add_u32 v14, s39, v8
    v_mov_b32 v12, v15
    v_add_u32 v15, s39, v9
    v_mov_b32 v13, v16
    v_add_u32 v16, s39, v10
    s_waitcnt lgkmcnt(15)
    v_mfma_f32_16x16x32_bf16 v[220:223], v[236:239], v[24:27], v[220:223]
    ds_read_b128 v[32:35], v12 offset:0
    v_mfma_f32_16x16x32_bf16 v[228:231], v[24:27], v[24:27], v[228:231]
    ds_read_b128 v[36:39], v12 offset:2048
    s_waitcnt lgkmcnt(15)
    v_mfma_f32_16x16x32_bf16 v[224:227], v[236:239], v[28:31], v[224:227]
    ds_read_b64_tr_b16 v[76:77], v13 offset:9216
    v_mfma_f32_16x16x32_bf16 v[232:235], v[28:31], v[28:31], v[232:235]
    ds_read_b64_tr_b16 v[78:79], v13 offset:11520
    s_waitcnt lgkmcnt(15)
    v_mfma_f32_16x16x32_bf16 v[112:115], v[40:43], v[24:27], v[112:115]
    ds_read_b64_tr_b16 v[80:81], v13 offset:9248
    v_mfma_f32_16x16x32_bf16 v[148:151], v[40:43], v[28:31], v[148:151]
    ds_read_b64_tr_b16 v[82:83], v13 offset:11552
    v_mfma_f32_16x16x32_bf16 v[116:119], v[44:47], v[24:27], v[116:119]
    ds_read_b64_tr_b16 v[84:85], v13 offset:9280
    v_mfma_f32_16x16x32_bf16 v[152:155], v[44:47], v[28:31], v[152:155]
    ds_read_b64_tr_b16 v[86:87], v13 offset:11584
    v_mfma_f32_16x16x32_bf16 v[120:123], v[48:51], v[24:27], v[120:123]
    ds_read_b64_tr_b16 v[88:89], v13 offset:9312
    v_mfma_f32_16x16x32_bf16 v[156:159], v[48:51], v[28:31], v[156:159]
    ds_read_b64_tr_b16 v[90:91], v13 offset:11616
    s_waitcnt lgkmcnt(15)
    v_mfma_f32_16x16x32_bf16 v[124:127], v[52:55], v[24:27], v[124:127]
    ds_read_b64_tr_b16 v[92:93], v13 offset:9344
    v_mfma_f32_16x16x32_bf16 v[160:163], v[52:55], v[28:31], v[160:163]
    ds_read_b64_tr_b16 v[94:95], v13 offset:11648
    v_mfma_f32_16x16x32_bf16 v[128:131], v[56:59], v[24:27], v[128:131]
    ds_read_b64_tr_b16 v[96:97], v13 offset:9376
    v_mfma_f32_16x16x32_bf16 v[164:167], v[56:59], v[28:31], v[164:167]
    ds_read_b64_tr_b16 v[98:99], v13 offset:11680
    v_mfma_f32_16x16x32_bf16 v[132:135], v[60:63], v[24:27], v[132:135]
    ds_read_b64_tr_b16 v[100:101], v13 offset:9408
    v_mfma_f32_16x16x32_bf16 v[168:171], v[60:63], v[28:31], v[168:171]
    ds_read_b64_tr_b16 v[102:103], v13 offset:11712
    s_waitcnt lgkmcnt(15)
    v_mfma_f32_16x16x32_bf16 v[136:139], v[64:67], v[24:27], v[136:139]
    ds_read_b64_tr_b16 v[104:105], v13 offset:9440
    v_mfma_f32_16x16x32_bf16 v[172:175], v[64:67], v[28:31], v[172:175]
    ds_read_b64_tr_b16 v[106:107], v13 offset:11744
    v_mfma_f32_16x16x32_bf16 v[140:143], v[68:71], v[24:27], v[140:143]
    ds_read_b64_tr_b16 v[108:109], v13 offset:9472
    v_mfma_f32_16x16x32_bf16 v[176:179], v[68:71], v[28:31], v[176:179]
    ds_read_b64_tr_b16 v[110:111], v13 offset:11776
    v_mfma_f32_16x16x32_bf16 v[144:147], v[72:75], v[24:27], v[144:147]
    v_mfma_f32_16x16x32_bf16 v[180:183], v[72:75], v[28:31], v[180:183]
    s_and_b32 s43, s42, 3
    s_add_u32 s42, s42, 1
    s_cmp_eq_u32 s43, s26
    s_cbranch_scc0 qkv_kernel_cw1
    v_mfma_f32_16x16x32_bf16 v[184:187], v[40:43], v[236:239], v[184:187]
    v_mfma_f32_16x16x32_bf16 v[188:191], v[44:47], v[236:239], v[188:191]
    v_mfma_f32_16x16x32_bf16 v[192:195], v[48:51], v[236:239], v[192:195]
    v_mfma_f32_16x16x32_bf16 v[196:199], v[52:55], v[236:239], v[196:199]
    v_mfma_f32_16x16x32_bf16 v[200:203], v[56:59], v[236:239], v[200:203]
    v_mfma_f32_16x16x32_bf16 v[204:207], v[60:63], v[236:239], v[204:207]
    v_mfma_f32_16x16x32_bf16 v[208:211], v[64:67], v[236:239], v[208:211]
    v_mfma_f32_16x16x32_bf16 v[212:215], v[68:71], v[236:239], v[212:215]
    v_mfma_f32_16x16x32_bf16 v[216:219], v[72:75], v[236:239], v[216:219]
qkv_kernel_cw1:
    s_barrier
    s_waitcnt lgkmcnt(15)
    v_mfma_f32_16x16x32_bf16 v[220:223], v[236:239], v[32:35], v[220:223]
    ds_read_b128 v[24:27], v14 offset:0
    v_mfma_f32_16x16x32_bf16 v[228:231], v[32:35], v[32:35], v[228:231]
    ds_read_b128 v[28:31], v14 offset:2048
    s_waitcnt lgkmcnt(15)
    v_mfma_f32_16x16x32_bf16 v[224:227], v[236:239], v[36:39], v[224:227]
    ds_read_b64_tr_b16 v[40:41], v16 offset:0
    v_mfma_f32_16x16x32_bf16 v[232:235], v[36:39], v[36:39], v[232:235]
    ds_read_b64_tr_b16 v[42:43], v16 offset:2304
    s_waitcnt lgkmcnt(15)
    v_mfma_f32_16x16x32_bf16 v[112:115], v[76:79], v[32:35], v[112:115]
    ds_read_b64_tr_b16 v[44:45], v16 offset:32
    v_mfma_f32_16x16x32_bf16 v[148:151], v[76:79], v[36:39], v[148:151]
    ds_read_b64_tr_b16 v[46:47], v16 offset:2336
    v_mfma_f32_16x16x32_bf16 v[116:119], v[80:83], v[32:35], v[116:119]
    ds_read_b64_tr_b16 v[48:49], v16 offset:64
    v_mfma_f32_16x16x32_bf16 v[152:155], v[80:83], v[36:39], v[152:155]
    ds_read_b64_tr_b16 v[50:51], v16 offset:2368
    v_mfma_f32_16x16x32_bf16 v[120:123], v[84:87], v[32:35], v[120:123]
    ds_read_b64_tr_b16 v[52:53], v16 offset:96
    v_mfma_f32_16x16x32_bf16 v[156:159], v[84:87], v[36:39], v[156:159]
    ds_read_b64_tr_b16 v[54:55], v16 offset:2400
    s_waitcnt lgkmcnt(15)
    v_mfma_f32_16x16x32_bf16 v[124:127], v[88:91], v[32:35], v[124:127]
    ds_read_b64_tr_b16 v[56:57], v16 offset:128
    v_mfma_f32_16x16x32_bf16 v[160:163], v[88:91], v[36:39], v[160:163]
    ds_read_b64_tr_b16 v[58:59], v16 offset:2432
    v_mfma_f32_16x16x32_bf16 v[128:131], v[92:95], v[32:35], v[128:131]
    ds_read_b64_tr_b16 v[60:61], v16 offset:160
    v_mfma_f32_16x16x32_bf16 v[164:167], v[92:95], v[36:39], v[164:167]
    ds_read_b64_tr_b16 v[62:63], v16 offset:2464
    v_mfma_f32_16x16x32_bf16 v[132:135], v[96:99], v[32:35], v[132:135]
    ds_read_b64_tr_b16 v[64:65], v16 offset:192
    v_mfma_f32_16x16x32_bf16 v[168:171], v[96:99], v[36:39], v[168:171]
    ds_read_b64_tr_b16 v[66:67], v16 offset:2496
    s_waitcnt lgkmcnt(15)
    v_mfma_f32_16x16x32_bf16 v[136:139], v[100:103], v[32:35], v[136:139]
    ds_read_b64_tr_b16 v[68:69], v16 offset:224
    v_mfma_f32_16x16x32_bf16 v[172:175], v[100:103], v[36:39], v[172:175]
    ds_read_b64_tr_b16 v[70:71], v16 offset:2528
    v_mfma_f32_16x16x32_bf16 v[140:143], v[104:107], v[32:35], v[140:143]
    ds_read_b64_tr_b16 v[72:73], v16 offset:256
    v_mfma_f32_16x16x32_bf16 v[176:179], v[104:107], v[36:39], v[176:179]
    ds_read_b64_tr_b16 v[74:75], v16 offset:2560
    v_mfma_f32_16x16x32_bf16 v[144:147], v[108:111], v[32:35], v[144:147]
    v_mfma_f32_16x16x32_bf16 v[180:183], v[108:111], v[36:39], v[180:183]
    s_and_b32 s43, s42, 3
    s_add_u32 s42, s42, 1
    s_cmp_eq_u32 s43, s26
    s_cbranch_scc0 qkv_kernel_cw2
    v_mfma_f32_16x16x32_bf16 v[184:187], v[76:79], v[236:239], v[184:187]
    v_mfma_f32_16x16x32_bf16 v[188:191], v[80:83], v[236:239], v[188:191]
    v_mfma_f32_16x16x32_bf16 v[192:195], v[84:87], v[236:239], v[192:195]
    v_mfma_f32_16x16x32_bf16 v[196:199], v[88:91], v[236:239], v[196:199]
    v_mfma_f32_16x16x32_bf16 v[200:203], v[92:95], v[236:239], v[200:203]
    v_mfma_f32_16x16x32_bf16 v[204:207], v[96:99], v[236:239], v[204:207]
    v_mfma_f32_16x16x32_bf16 v[208:211], v[100:103], v[236:239], v[208:211]
    v_mfma_f32_16x16x32_bf16 v[212:215], v[104:107], v[236:239], v[212:215]
    v_mfma_f32_16x16x32_bf16 v[216:219], v[108:111], v[236:239], v[216:219]
qkv_kernel_cw2:
    s_add_u32 s40, s40, 1
    s_cmp_lt_u32 s40, 9
    s_cbranch_scc1 qkv_kernel_loop0
    s_waitcnt lgkmcnt(0)
    s_nop 7
    s_barrier
    s_mul_i32 s40, s26, 576
    v_lshlrev_b32 v24, 4, v2
    v_add_u32 v25, s40, v24
    ds_write_b128 v25, v[184:187] offset:0
    ds_write_b128 v25, v[188:191] offset:64
    ds_write_b128 v25, v[192:195] offset:128
    ds_write_b128 v25, v[196:199] offset:192
    ds_write_b128 v25, v[200:203] offset:256
    ds_write_b128 v25, v[204:207] offset:320
    ds_write_b128 v25, v[208:211] offset:384
    ds_write_b128 v25, v[212:215] offset:448
    ds_write_b128 v25, v[216:219] offset:512
    v_and_b32 v26, 3, v3
    v_lshrrev_b32 v27, 2, v3
    v_lshl_add_u32 v27, v27, 4, v3
    v_lshlrev_b32 v27, 2, v27
    v_cmp_eq_u32 vcc, 1, v26
    s_nop 1
    v_cndmask_b32 v28, v228, v229, vcc
    v_cmp_eq_u32 vcc, 2, v26
    s_nop 1
    v_cndmask_b32 v28, v28, v230, vcc
    v_cmp_eq_u32 vcc, 3, v26
    s_nop 1
    v_cndmask_b32 v28, v28, v231, vcc
    ds_bpermute_b32 v30, v27, v28
    v_cmp_eq_u32 vcc, 1, v26
    s_nop 1
    v_cndmask_b32 v29, v232, v233, vcc
    v_cmp_eq_u32 vcc, 2, v26
    s_nop 1
    v_cndmask_b32 v29, v29, v234, vcc
    v_cmp_eq_u32 vcc, 3, v26
    s_nop 1
    v_cndmask_b32 v29, v29, v235, vcc
    ds_bpermute_b32 v31, v27, v29
    s_mov_b32 s44, 0x3ae38e39
    s_mov_b32 s45, 0x3727c5ac
    s_waitcnt lgkmcnt(0)
    v_mul_f32 v28, s44, v220
    v_mul_f32 v30, s44, v30
    v_fma_f32 v30, -v28, v28, v30
    v_max_f32 v30, 0, v30
    v_add_f32 v30, s45, v30
    v_rsq_f32 v32, v30
    v_mul_f32 v29, s44, v224
    v_mul_f32 v31, s44, v31
    v_fma_f32 v31, -v29, v29, v31
    v_max_f32 v31, 0, v31
    v_add_f32 v31, s45, v31
    v_rsq_f32 v33, v31
    s_nop 0
    s_mov_b32 s43, 0x3eae1a93
    s_cmp_eq_u32 s41, 0
    s_cselect_b32 s43, s43, 1.0
    v_mul_f32 v32, s43, v32
    v_mul_f32 v33, s43, v33
    v_mul_f32 v34, v28, v32
    v_mul_f32 v35, v29, v33
    s_barrier
    s_and_b32 s44, s25, 3
    s_lshl_b32 s44, s44, 3
    s_lshl_b32 s27, s24, 7
    s_lshl_b32 s30, s26, 5
    s_add_u32 s27, s27, s30
    s_mul_i32 s47, s26, 12288
    s_add_u32 s47, s47, 4096
    s_lshr_b32 s48, s27, 9
    s_mul_i32 s48, s48, 39936
    s_and_b32 s49, s27, 511
    s_mul_i32 s50, s44, 159744
    s_add_u32 s48, s48, s50
    ds_read_b128 v[40:43], v24 offset:0
    ds_read_b128 v[76:79], v24 offset:576
    ds_read_b128 v[44:47], v24 offset:64
    ds_read_b128 v[80:83], v24 offset:640
    ds_read_b128 v[48:51], v24 offset:128
    ds_read_b128 v[84:87], v24 offset:704
    ds_read_b128 v[52:55], v24 offset:192
    ds_read_b128 v[88:91], v24 offset:768
    ds_read_b128 v[56:59], v24 offset:256
    ds_read_b128 v[92:95], v24 offset:832
    ds_read_b128 v[60:63], v24 offset:320
    ds_read_b128 v[96:99], v24 offset:896
    ds_read_b128 v[64:67], v24 offset:384
    ds_read_b128 v[100:103], v24 offset:960
    ds_read_b128 v[68:71], v24 offset:448
    ds_read_b128 v[104:107], v24 offset:1024
    ds_read_b128 v[72:75], v24 offset:512
    ds_read_b128 v[108:111], v24 offset:1088
    s_waitcnt lgkmcnt(0)
    v_add_f32 v40, v40, v76
    v_add_f32 v41, v41, v77
    v_add_f32 v42, v42, v78
    v_add_f32 v43, v43, v79
    v_add_f32 v44, v44, v80
    v_add_f32 v45, v45, v81
    v_add_f32 v46, v46, v82
    v_add_f32 v47, v47, v83
    v_add_f32 v48, v48, v84
    v_add_f32 v49, v49, v85
    v_add_f32 v50, v50, v86
    v_add_f32 v51, v51, v87
    v_add_f32 v52, v52, v88
    v_add_f32 v53, v53, v89
    v_add_f32 v54, v54, v90
    v_add_f32 v55, v55, v91
    v_add_f32 v56, v56, v92
    v_add_f32 v57, v57, v93
    v_add_f32 v58, v58, v94
    v_add_f32 v59, v59, v95
    v_add_f32 v60, v60, v96
    v_add_f32 v61, v61, v97
    v_add_f32 v62, v62, v98
    v_add_f32 v63, v63, v99
    v_add_f32 v64, v64, v100
    v_add_f32 v65, v65, v101
    v_add_f32 v66, v66, v102
    v_add_f32 v67, v67, v103
    v_add_f32 v68, v68, v104
    v_add_f32 v69, v69, v105
    v_add_f32 v70, v70, v106
    v_add_f32 v71, v71, v107
    v_add_f32 v72, v72, v108
    v_add_f32 v73, v73, v109
    v_add_f32 v74, v74, v110
    v_add_f32 v75, v75, v111
    ds_read_b128 v[76:79], v24 offset:1152
    ds_read_b128 v[184:187], v24 offset:1728
    ds_read_b128 v[80:83], v24 offset:1216
    ds_read_b128 v[188:191], v24 offset:1792
    ds_read_b128 v[84:87], v24 offset:1280
    ds_read_b128 v[192:195], v24 offset:1856
    ds_read_b128 v[88:91], v24 offset:1344
    ds_read_b128 v[196:199], v24 offset:1920
    ds_read_b128 v[92:95], v24 offset:1408
    ds_read_b128 v[200:203], v24 offset:1984
    ds_read_b128 v[96:99], v24 offset:1472
    ds_read_b128 v[204:207], v24 offset:2048
    ds_read_b128 v[100:103], v24 offset:1536
    ds_read_b128 v[208:211], v24 offset:2112
    ds_read_b128 v[104:107], v24 offset:1600
    ds_read_b128 v[212:215], v24 offset:2176
    ds_read_b128 v[108:111], v24 offset:1664
    ds_read_b128 v[216:219], v24 offset:2240
    s_waitcnt lgkmcnt(0)
    v_add_f32 v76, v76, v184
    v_add_f32 v40, v40, v76
    v_add_f32 v77, v77, v185
    v_add_f32 v41, v41, v77
    v_add_f32 v78, v78, v186
    v_add_f32 v42, v42, v78
    v_add_f32 v79, v79, v187
    v_add_f32 v43, v43, v79
    v_add_f32 v80, v80, v188
    v_add_f32 v44, v44, v80
    v_add_f32 v81, v81, v189
    v_add_f32 v45, v45, v81
    v_add_f32 v82, v82, v190
    v_add_f32 v46, v46, v82
    v_add_f32 v83, v83, v191
    v_add_f32 v47, v47, v83
    v_add_f32 v84, v84, v192
    v_add_f32 v48, v48, v84
    v_add_f32 v85, v85, v193
    v_add_f32 v49, v49, v85
    v_add_f32 v86, v86, v194
    v_add_f32 v50, v50, v86
    v_add_f32 v87, v87, v195
    v_add_f32 v51, v51, v87
    v_add_f32 v88, v88, v196
    v_add_f32 v52, v52, v88
    v_add_f32 v89, v89, v197
    v_add_f32 v53, v53, v89
    v_add_f32 v90, v90, v198
    v_add_f32 v54, v54, v90
    v_add_f32 v91, v91, v199
    v_add_f32 v55, v55, v91
    v_add_f32 v92, v92, v200
    v_add_f32 v56, v56, v92
    v_add_f32 v93, v93, v201
    v_add_f32 v57, v57, v93
    v_add_f32 v94, v94, v202
    v_add_f32 v58, v58, v94
    v_add_f32 v95, v95, v203
    v_add_f32 v59, v59, v95
    v_add_f32 v96, v96, v204
    v_add_f32 v60, v60, v96
    v_add_f32 v97, v97, v205
    v_add_f32 v61, v61, v97
    v_add_f32 v98, v98, v206
    v_add_f32 v62, v62, v98
    v_add_f32 v99, v99, v207
    v_add_f32 v63, v63, v99
    v_add_f32 v100, v100, v208
    v_add_f32 v64, v64, v100
    v_add_f32 v101, v101, v209
    v_add_f32 v65, v65, v101
    v_add_f32 v102, v102, v210
    v_add_f32 v66, v66, v102
    v_add_f32 v103, v103, v211
    v_add_f32 v67, v67, v103
    v_add_f32 v104, v104, v212
    v_add_f32 v68, v68, v104
    v_add_f32 v105, v105, v213
    v_add_f32 v69, v69, v105
    v_add_f32 v106, v106, v214
    v_add_f32 v70, v70, v106
    v_add_f32 v107, v107, v215
    v_add_f32 v71, v71, v107
    v_add_f32 v108, v108, v216
    v_add_f32 v72, v72, v108
    v_add_f32 v109, v109, v217
    v_add_f32 v73, v73, v109
    v_add_f32 v110, v110, v218
    v_add_f32 v74, v74, v110
    v_add_f32 v111, v111, v219
    v_add_f32 v75, v75, v111
    v_mul_u32_u24 v36, 296, v3
    v_lshl_add_u32 v36, v2, 3, v36
    v_add_u32 v36, s47, v36
    v_mul_f32 v96, v40, v34
    v_mul_f32 v97, v41, v34
    v_mul_f32 v98, v42, v34
    v_mul_f32 v99, v43, v34
    v_fma_f32 v96, v112, v32, -v96
    v_fma_f32 v97, v113, v32, -v97
    v_fma_f32 v98, v114, v32, -v98
    v_fma_f32 v99, v115, v32, -v99
    v_cvt_pk_bf16_f32 v112, v96, v97
    v_cvt_pk_bf16_f32 v113, v98, v99
    ds_write_b64 v36, v[112:113] offset:0
    v_mul_f32 v96, v44, v34
    v_mul_f32 v97, v45, v34
    v_mul_f32 v98, v46, v34
    v_mul_f32 v99, v47, v34
    v_fma_f32 v96, v116, v32, -v96
    v_fma_f32 v97, v117, v32, -v97
    v_fma_f32 v98, v118, v32, -v98
    v_fma_f32 v99, v119, v32, -v99
    v_cvt_pk_bf16_f32 v116, v96, v97
    v_cvt_pk_bf16_f32 v117, v98, v99
    ds_write_b64 v36, v[116:117] offset:32
    v_mul_f32 v96, v48, v34
    v_mul_f32 v97, v49, v34
    v_mul_f32 v98, v50, v34
    v_mul_f32 v99, v51, v34
    v_fma_f32 v96, v120, v32, -v96
    v_fma_f32 v97, v121, v32, -v97
    v_fma_f32 v98, v122, v32, -v98
    v_fma_f32 v99, v123, v32, -v99
    v_cvt_pk_bf16_f32 v120, v96, v97
    v_cvt_pk_bf16_f32 v121, v98, v99
    ds_write_b64 v36, v[120:121] offset:64
    v_mul_f32 v96, v52, v34
    v_mul_f32 v97, v53, v34
    v_mul_f32 v98, v54, v34
    v_mul_f32 v99, v55, v34
    v_fma_f32 v96, v124, v32, -v96
    v_fma_f32 v97, v125, v32, -v97
    v_fma_f32 v98, v126, v32, -v98
    v_fma_f32 v99, v127, v32, -v99
    v_cvt_pk_bf16_f32 v124, v96, v97
    v_cvt_pk_bf16_f32 v125, v98, v99
    ds_write_b64 v36, v[124:125] offset:96
    v_mul_f32 v96, v56, v34
    v_mul_f32 v97, v57, v34
    v_mul_f32 v98, v58, v34
    v_mul_f32 v99, v59, v34
    v_fma_f32 v96, v128, v32, -v96
    v_fma_f32 v97, v129, v32, -v97
    v_fma_f32 v98, v130, v32, -v98
    v_fma_f32 v99, v131, v32, -v99
    v_cvt_pk_bf16_f32 v128, v96, v97
    v_cvt_pk_bf16_f32 v129, v98, v99
    ds_write_b64 v36, v[128:129] offset:128
    v_mul_f32 v96, v60, v34
    v_mul_f32 v97, v61, v34
    v_mul_f32 v98, v62, v34
    v_mul_f32 v99, v63, v34
    v_fma_f32 v96, v132, v32, -v96
    v_fma_f32 v97, v133, v32, -v97
    v_fma_f32 v98, v134, v32, -v98
    v_fma_f32 v99, v135, v32, -v99
    v_cvt_pk_bf16_f32 v132, v96, v97
    v_cvt_pk_bf16_f32 v133, v98, v99
    ds_write_b64 v36, v[132:133] offset:160
    v_mul_f32 v96, v64, v34
    v_mul_f32 v97, v65, v34
    v_mul_f32 v98, v66, v34
    v_mul_f32 v99, v67, v34
    v_fma_f32 v96, v136, v32, -v96
    v_fma_f32 v97, v137, v32, -v97
    v_fma_f32 v98, v138, v32, -v98
    v_fma_f32 v99, v139, v32, -v99
    v_cvt_pk_bf16_f32 v136, v96, v97
    v_cvt_pk_bf16_f32 v137, v98, v99
    ds_write_b64 v36, v[136:137] offset:192
    v_mul_f32 v96, v68, v34
    v_mul_f32 v97, v69, v34
    v_mul_f32 v98, v70, v34
    v_mul_f32 v99, v71, v34
    v_fma_f32 v96, v140, v32, -v96
    v_fma_f32 v97, v141, v32, -v97
    v_fma_f32 v98, v142, v32, -v98
    v_fma_f32 v99, v143, v32, -v99
    v_cvt_pk_bf16_f32 v140, v96, v97
    v_cvt_pk_bf16_f32 v141, v98, v99
    ds_write_b64 v36, v[140:141] offset:224
    v_mul_f32 v96, v72, v34
    v_mul_f32 v97, v73, v34
    v_mul_f32 v98, v74, v34
    v_mul_f32 v99, v75, v34
    v_fma_f32 v96, v144, v32, -v96
    v_fma_f32 v97, v145, v32, -v97
    v_fma_f32 v98, v146, v32, -v98
    v_fma_f32 v99, v147, v32, -v99
    v_cvt_pk_bf16_f32 v144, v96, v97
    v_cvt_pk_bf16_f32 v145, v98, v99
    ds_write_b64 v36, v[144:145] offset:256
    v_mul_f32 v96, v40, v35
    v_mul_f32 v97, v41, v35
    v_mul_f32 v98, v42, v35
    v_mul_f32 v99, v43, v35
    v_fma_f32 v96, v148, v33, -v96
    v_fma_f32 v97, v149, v33, -v97
    v_fma_f32 v98, v150, v33, -v98
    v_fma_f32 v99, v151, v33, -v99
    v_cvt_pk_bf16_f32 v148, v96, v97
    v_cvt_pk_bf16_f32 v149, v98, v99
    ds_write_b64 v36, v[148:149] offset:4736
    v_mul_f32 v96, v44, v35
    v_mul_f32 v97, v45, v35
    v_mul_f32 v98, v46, v35
    v_mul_f32 v99, v47, v35
    v_fma_f32 v96, v152, v33, -v96
    v_fma_f32 v97, v153, v33, -v97
    v_fma_f32 v98, v154, v33, -v98
    v_fma_f32 v99, v155, v33, -v99
    v_cvt_pk_bf16_f32 v152, v96, v97
    v_cvt_pk_bf16_f32 v153, v98, v99
    ds_write_b64 v36, v[152:153] offset:4768
    v_mul_f32 v96, v48, v35
    v_mul_f32 v97, v49, v35
    v_mul_f32 v98, v50, v35
    v_mul_f32 v99, v51, v35
    v_fma_f32 v96, v156, v33, -v96
    v_fma_f32 v97, v157, v33, -v97
    v_fma_f32 v98, v158, v33, -v98
    v_fma_f32 v99, v159, v33, -v99
    v_cvt_pk_bf16_f32 v156, v96, v97
    v_cvt_pk_bf16_f32 v157, v98, v99
    ds_write_b64 v36, v[156:157] offset:4800
    v_mul_f32 v96, v52, v35
    v_mul_f32 v97, v53, v35
    v_mul_f32 v98, v54, v35
    v_mul_f32 v99, v55, v35
    v_fma_f32 v96, v160, v33, -v96
    v_fma_f32 v97, v161, v33, -v97
    v_fma_f32 v98, v162, v33, -v98
    v_fma_f32 v99, v163, v33, -v99
    v_cvt_pk_bf16_f32 v160, v96, v97
    v_cvt_pk_bf16_f32 v161, v98, v99
    ds_write_b64 v36, v[160:161] offset:4832
    v_mul_f32 v96, v56, v35
    v_mul_f32 v97, v57, v35
    v_mul_f32 v98, v58, v35
    v_mul_f32 v99, v59, v35
    v_fma_f32 v96, v164, v33, -v96
    v_fma_f32 v97, v165, v33, -v97
    v_fma_f32 v98, v166, v33, -v98
    v_fma_f32 v99, v167, v33, -v99
    v_cvt_pk_bf16_f32 v164, v96, v97
    v_cvt_pk_bf16_f32 v165, v98, v99
    ds_write_b64 v36, v[164:165] offset:4864
    v_mul_f32 v96, v60, v35
    v_mul_f32 v97, v61, v35
    v_mul_f32 v98, v62, v35
    v_mul_f32 v99, v63, v35
    v_fma_f32 v96, v168, v33, -v96
    v_fma_f32 v97, v169, v33, -v97
    v_fma_f32 v98, v170, v33, -v98
    v_fma_f32 v99, v171, v33, -v99
    v_cvt_pk_bf16_f32 v168, v96, v97
    v_cvt_pk_bf16_f32 v169, v98, v99
    ds_write_b64 v36, v[168:169] offset:4896
    v_mul_f32 v96, v64, v35
    v_mul_f32 v97, v65, v35
    v_mul_f32 v98, v66, v35
    v_mul_f32 v99, v67, v35
    v_fma_f32 v96, v172, v33, -v96
    v_fma_f32 v97, v173, v33, -v97
    v_fma_f32 v98, v174, v33, -v98
    v_fma_f32 v99, v175, v33, -v99
    v_cvt_pk_bf16_f32 v172, v96, v97
    v_cvt_pk_bf16_f32 v173, v98, v99
    ds_write_b64 v36, v[172:173] offset:4928
    v_mul_f32 v96, v68, v35
    v_mul_f32 v97, v69, v35
    v_mul_f32 v98, v70, v35
    v_mul_f32 v99, v71, v35
    v_fma_f32 v96, v176, v33, -v96
    v_fma_f32 v97, v177, v33, -v97
    v_fma_f32 v98, v178, v33, -v98
    v_fma_f32 v99, v179, v33, -v99
    v_cvt_pk_bf16_f32 v176, v96, v97
    v_cvt_pk_bf16_f32 v177, v98, v99
    ds_write_b64 v36, v[176:177] offset:4960
    v_mul_f32 v96, v72, v35
    v_mul_f32 v97, v73, v35
    v_mul_f32 v98, v74, v35
    v_mul_f32 v99, v75, v35
    v_fma_f32 v96, v180, v33, -v96
    v_fma_f32 v97, v181, v33, -v97
    v_fma_f32 v98, v182, v33, -v98
    v_fma_f32 v99, v183, v33, -v99
    v_cvt_pk_bf16_f32 v180, v96, v97
    v_cvt_pk_bf16_f32 v181, v98, v99
    ds_write_b64 v36, v[180:181] offset:4992
    s_waitcnt lgkmcnt(0)
    s_cmp_eq_u32 s41, 0
    s_cbranch_scc1 qkv_kernel_isq3
    v_and_b32 v37, 31, v1
    v_lshrrev_b32 v38, 5, v1
    v_mul_u32_u24 v39, 296, v37
    v_add_u32 v39, s47, v39
    v_lshl_add_u32 v40, v38, 4, v39
    v_lshlrev_b32 v41, 4, v1
    s_lshr_b32 s50, s49, 5
    s_lshl_b32 s50, s50, 10
    s_add_u32 s50, s50, s48
    ds_read2_b32 v[48:49], v40 offset0:0 offset1:1
    ds_read2_b32 v[50:51], v40 offset0:2 offset1:3
    ds_read2_b32 v[52:53], v40 offset0:9 offset1:10
    ds_read2_b32 v[54:55], v40 offset0:11 offset1:12
    ds_read2_b32 v[56:57], v40 offset0:18 offset1:19
    ds_read2_b32 v[58:59], v40 offset0:20 offset1:21
    ds_read2_b32 v[60:61], v40 offset0:27 offset1:28
    ds_read2_b32 v[62:63], v40 offset0:29 offset1:30
    ds_read2_b32 v[64:65], v40 offset0:36 offset1:37
    ds_read2_b32 v[66:67], v40 offset0:38 offset1:39
    ds_read2_b32 v[68:69], v40 offset0:45 offset1:46
    ds_read2_b32 v[70:71], v40 offset0:47 offset1:48
    ds_read2_b32 v[72:73], v40 offset0:54 offset1:55
    ds_read2_b32 v[74:75], v40 offset0:56 offset1:57
    ds_read2_b32 v[76:77], v40 offset0:63 offset1:64
    ds_read2_b32 v[78:79], v40 offset0:65 offset1:66
    v_mul_u32_u24 v42, 36, v38
    v_add_u32 v42, v42, v39
    ds_read_b32 v80, v42 offset:32
    ds_read_b32 v82, v42 offset:104
    ds_read_b32 v84, v42 offset:176
    ds_read_b32 v86, v42 offset:248
    v_mov_b32 v81, 0x00003f80
    v_mov_b32 v83, 0x00003f80
    v_mov_b32 v85, 0x00003f80
    v_mov_b32 v87, 0x00003f80
    s_mov_b32 s51, 159744
    v_mul_lo_u32 v43, v38, s51
    v_lshl_add_u32 v43, v37, 3, v43
    s_lshl_b32 s51, s49, 3
    s_add_u32 s51, s51, s48
    s_add_u32 s51, s51, 16384
    s_waitcnt lgkmcnt(0)
    buffer_store_dwordx4 v[48:51], v41, s[20:23], s50 offen
    s_add_u32 s50, s50, 159744
    buffer_store_dwordx4 v[52:55], v41, s[20:23], s50 offen
    s_add_u32 s50, s50, 159744
    buffer_store_dwordx4 v[56:59], v41, s[20:23], s50 offen
    s_add_u32 s50, s50, 159744
    buffer_store_dwordx4 v[60:63], v41, s[20:23], s50 offen
    s_add_u32 s50, s50, 159744
    buffer_store_dwordx4 v[64:67], v41, s[20:23], s50 offen
    s_add_u32 s50, s50, 159744
    buffer_store_dwordx4 v[68:71], v41, s[20:23], s50 offen
    s_add_u32 s50, s50, 159744
    buffer_store_dwordx4 v[72:75], v41, s[20:23], s50 offen
    s_add_u32 s50, s50, 159744
    buffer_store_dwordx4 v[76:79], v41, s[20:23], s50 offen
    buffer_store_dwordx2 v[80:81], v43, s[20:23], s51 offen
    s_add_u32 s51, s51, 319488
    buffer_store_dwordx2 v[82:83], v43, s[20:23], s51 offen
    s_add_u32 s51, s51, 319488
    buffer_store_dwordx2 v[84:85], v43, s[20:23], s51 offen
    s_add_u32 s51, s51, 319488
    buffer_store_dwordx2 v[86:87], v43, s[20:23], s51 offen
    s_branch qkv_kernel_done
qkv_kernel_isq3:
    v_add_u32 v37, 0, v1
    v_cmp_le_u32 vcc, 96, v37
    s_nop 1
    v_cndmask_b32 v38, 0, 1, vcc
    v_mul_u32_u24 v39, 96, v38
    v_sub_u32 v37, v37, v39
    v_mul_u32_u24 v39, 171, v37
    v_lshrrev_b32 v39, 9, v39
    v_mul_u32_u24 v40, 3, v39
    v_sub_u32 v40, v37, v40
    v_mul_u32_u24 v41, 296, v39
    v_mul_u32_u24 v42, 36, v38
    v_add_u32 v41, v41, v42
    v_lshl_add_u32 v41, v40, 4, v41
    v_add_u32 v44, s47, v41
    v_mul_u32_u24 v41, 48, v39
    v_lshl_add_u32 v41, v40, 4, v41
    s_mov_b32 s51, 98304
    v_mul_lo_u32 v42, v38, s51
    v_add_u32 v100, v41, v42
    v_add_u32 v37, 64, v1
    v_cmp_le_u32 vcc, 96, v37
    s_nop 1
    v_cndmask_b32 v38, 0, 1, vcc
    v_mul_u32_u24 v39, 96, v38
    v_sub_u32 v37, v37, v39
    v_mul_u32_u24 v39, 171, v37
    v_lshrrev_b32 v39, 9, v39
    v_mul_u32_u24 v40, 3, v39
    v_sub_u32 v40, v37, v40
    v_mul_u32_u24 v41, 296, v39
    v_mul_u32_u24 v42, 36, v38
    v_add_u32 v41, v41, v42
    v_lshl_add_u32 v41, v40, 4, v41
    v_add_u32 v45, s47, v41
    v_mul_u32_u24 v41, 48, v39
    v_lshl_add_u32 v41, v40, 4, v41
    s_mov_b32 s51, 98304
    v_mul_lo_u32 v42, v38, s51
    v_add_u32 v101, v41, v42
    v_add_u32 v37, 128, v1
    v_cmp_le_u32 vcc, 96, v37
    s_nop 1
    v_cndmask_b32 v38, 0, 1, vcc
    v_mul_u32_u24 v39, 96, v38
    v_sub_u32 v37, v37, v39
    v_mul_u32_u24 v39, 171, v37
    v_lshrrev_b32 v39, 9, v39
    v_mul_u32_u24 v40, 3, v39
    v_sub_u32 v40, v37, v40
    v_mul_u32_u24 v41, 296, v39
    v_mul_u32_u24 v42, 36, v38
    v_add_u32 v41, v41, v42
    v_lshl_add_u32 v41, v40, 4, v41
    v_add_u32 v46, s47, v41
    v_mul_u32_u24 v41, 48, v39
    v_lshl_add_u32 v41, v40, 4, v41
    s_mov_b32 s51, 98304
    v_mul_lo_u32 v42, v38, s51
    v_add_u32 v102, v41, v42
    ds_read2_b32 v[48:49], v44 offset0:0 offset1:1
    ds_read2_b32 v[50:51], v44 offset0:2 offset1:3
    ds_read2_b32 v[52:53], v45 offset0:0 offset1:1
    ds_read2_b32 v[54:55], v45 offset0:2 offset1:3
    ds_read2_b32 v[56:57], v46 offset0:0 offset1:1
    ds_read2_b32 v[58:59], v46 offset0:2 offset1:3
    ds_read2_b32 v[60:61], v44 offset0:18 offset1:19
    ds_read2_b32 v[62:63], v44 offset0:20 offset1:21
    ds_read2_b32 v[64:65], v45 offset0:18 offset1:19
    ds_read2_b32 v[66:67], v45 offset0:20 offset1:21
    ds_read2_b32 v[68:69], v46 offset0:18 offset1:19
    ds_read2_b32 v[70:71], v46 offset0:20 offset1:21
    ds_read2_b32 v[72:73], v44 offset0:36 offset1:37
    ds_read2_b32 v[74:75], v44 offset0:38 offset1:39
    ds_read2_b32 v[76:77], v45 offset0:36 offset1:37
    ds_read2_b32 v[78:79], v45 offset0:38 offset1:39
    ds_read2_b32 v[80:81], v46 offset0:36 offset1:37
    ds_read2_b32 v[82:83], v46 offset0:38 offset1:39
    ds_read2_b32 v[84:85], v44 offset0:54 offset1:55
    ds_read2_b32 v[86:87], v44 offset0:56 offset1:57
    ds_read2_b32 v[88:89], v45 offset0:54 offset1:55
    ds_read2_b32 v[90:91], v45 offset0:56 offset1:57
    ds_read2_b32 v[92:93], v46 offset0:54 offset1:55
    ds_read2_b32 v[94:95], v46 offset0:56 offset1:57
    s_lshl_b32 s50, s44, 11
    s_add_u32 s50, s50, s27
    s_mul_i32 s50, s50, 48
    s_waitcnt lgkmcnt(0)
    buffer_store_dwordx4 v[48:51], v100, s[16:19], s50 offen
    buffer_store_dwordx4 v[52:55], v101, s[16:19], s50 offen
    buffer_store_dwordx4 v[56:59], v102, s[16:19], s50 offen
    s_add_u32 s50, s50, 196608
    buffer_store_dwordx4 v[60:63], v100, s[16:19], s50 offen
    buffer_store_dwordx4 v[64:67], v101, s[16:19], s50 offen
    buffer_store_dwordx4 v[68:71], v102, s[16:19], s50 offen
    s_add_u32 s50, s50, 196608
    buffer_store_dwordx4 v[72:75], v100, s[16:19], s50 offen
    buffer_store_dwordx4 v[76:79], v101, s[16:19], s50 offen
    buffer_store_dwordx4 v[80:83], v102, s[16:19], s50 offen
    s_add_u32 s50, s50, 196608
    buffer_store_dwordx4 v[84:87], v100, s[16:19], s50 offen
    buffer_store_dwordx4 v[88:91], v101, s[16:19], s50 offen
    buffer_store_dwordx4 v[92:95], v102, s[16:19], s50 offen
    s_branch qkv_kernel_done
qkv_kernel_var1:
    ds_read_b128 v[24:27], v14 offset:0
    ds_read_b128 v[28:31], v14 offset:2048
    ds_read_b64_tr_b16 v[40:41], v16 offset:0
    ds_read_b64_tr_b16 v[42:43], v16 offset:2304
    ds_read_b64_tr_b16 v[44:45], v16 offset:32
    ds_read_b64_tr_b16 v[46:47], v16 offset:2336
    ds_read_b64_tr_b16 v[48:49], v16 offset:64
    ds_read_b64_tr_b16 v[50:51], v16 offset:2368
    ds_read_b64_tr_b16 v[52:53], v16 offset:96
    ds_read_b64_tr_b16 v[54:55], v16 offset:2400
    ds_read_b64_tr_b16 v[56:57], v16 offset:128
    ds_read_b64_tr_b16 v[58:59], v16 offset:2432
    ds_read_b64_tr_b16 v[60:61], v16 offset:160
    ds_read_b64_tr_b16 v[62:63], v16 offset:2464
    ds_read_b64_tr_b16 v[64:65], v16 offset:192
    ds_read_b64_tr_b16 v[66:67], v16 offset:2496
    ds_read_b64_tr_b16 v[68:69], v16 offset:224
    ds_read_b64_tr_b16 v[70:71], v16 offset:2528
    ds_read_b64_tr_b16 v[72:73], v16 offset:256
    ds_read_b64_tr_b16 v[74:75], v16 offset:2560
qkv_kernel_loop1:
    s_add_u32 s39, s39, 34816
    s_cmp_eq_u32 s39, 139264
    s_cselect_b32 s39, 0, s39
    v_mov_b32 v11, v14
    v_add_u32 v14, s39, v8
    v_mov_b32 v12, v15
    v_add_u32 v15, s39, v9
    v_mov_b32 v13, v16
    v_add_u32 v16, s39, v10
    s_waitcnt lgkmcnt(15)
    v_mfma_f32_16x16x32_bf16 v[220:223], v[236:239], v[24:27], v[220:223]
    ds_read_b128 v[32:35], v12 offset:0
    v_mfma_f32_16x16x32_bf16 v[228:231], v[24:27], v[24:27], v[228:231]
    ds_read_b128 v[36:39], v12 offset:2048
    s_waitcnt lgkmcnt(15)
    v_mfma_f32_16x16x32_bf16 v[224:227], v[236:239], v[28:31], v[224:227]
    ds_read_b64_tr_b16 v[76:77], v13 offset:9216
    v_mfma_f32_16x16x32_bf16 v[232:235], v[28:31], v[28:31], v[232:235]
    ds_read_b64_tr_b16 v[78:79], v13 offset:11520
    s_waitcnt lgkmcnt(15)
    v_mfma_f32_16x16x32_bf16 v[112:115], v[24:27], v[40:43], v[112:115]
    ds_read_b64_tr_b16 v[80:81], v13 offset:9248
    v_mfma_f32_16x16x32_bf16 v[148:151], v[28:31], v[40:43], v[148:151]
    ds_read_b64_tr_b16 v[82:83], v13 offset:11552
    v_mfma_f32_16x16x32_bf16 v[116:119], v[24:27], v[44:47], v[116:119]
    ds_read_b64_tr_b16 v[84:85], v13 offset:9280
    v_mfma_f32_16x16x32_bf16 v[152:155], v[28:31], v[44:47], v[152:155]
    ds_read_b64_tr_b16 v[86:87], v13 offset:11584
    v_mfma_f32_16x16x32_bf16 v[120:123], v[24:27], v[48:51], v[120:123]
    ds_read_b64_tr_b16 v[88:89], v13 offset:9312
    v_mfma_f32_16x16x32_bf16 v[156:159], v[28:31], v[48:51], v[156:159]
    ds_read_b64_tr_b16 v[90:91], v13 offset:11616
    s_waitcnt lgkmcnt(15)
    v_mfma_f32_16x16x32_bf16 v[124:127], v[24:27], v[52:55], v[124:127]
    ds_read_b64_tr_b16 v[92:93], v13 offset:9344
    v_mfma_f32_16x16x32_bf16 v[160:163], v[28:31], v[52:55], v[160:163]
    ds_read_b64_tr_b16 v[94:95], v13 offset:11648
    v_mfma_f32_16x16x32_bf16 v[128:131], v[24:27], v[56:59], v[128:131]
    ds_read_b64_tr_b16 v[96:97], v13 offset:9376
    v_mfma_f32_16x16x32_bf16 v[164:167], v[28:31], v[56:59], v[164:167]
    ds_read_b64_tr_b16 v[98:99], v13 offset:11680
    v_mfma_f32_16x16x32_bf16 v[132:135], v[24:27], v[60:63], v[132:135]
    ds_read_b64_tr_b16 v[100:101], v13 offset:9408
    v_mfma_f32_16x16x32_bf16 v[168:171], v[28:31], v[60:63], v[168:171]
    ds_read_b64_tr_b16 v[102:103], v13 offset:11712
    s_waitcnt lgkmcnt(15)
    v_mfma_f32_16x16x32_bf16 v[136:139], v[24:27], v[64:67], v[136:139]
    ds_read_b64_tr_b16 v[104:105], v13 offset:9440
    v_mfma_f32_16x16x32_bf16 v[172:175], v[28:31], v[64:67], v[172:175]
    ds_read_b64_tr_b16 v[106:107], v13 offset:11744
    v_mfma_f32_16x16x32_bf16 v[140:143], v[24:27], v[68:71], v[140:143]
    ds_read_b64_tr_b16 v[108:109], v13 offset:9472
    v_mfma_f32_16x16x32_bf16 v[176:179], v[28:31], v[68:71], v[176:179]
    ds_read_b64_tr_b16 v[110:111], v13 offset:11776
    v_mfma_f32_16x16x32_bf16 v[144:147], v[24:27], v[72:75], v[144:147]
    v_mfma_f32_16x16x32_bf16 v[180:183], v[28:31], v[72:75], v[180:183]
    s_and_b32 s43, s42, 3
    s_add_u32 s42, s42, 1
    s_cmp_eq_u32 s43, s26
    s_cbranch_scc0 qkv_kernel_cw4
    v_mfma_f32_16x16x32_bf16 v[184:187], v[236:239], v[40:43], v[184:187]
    v_mfma_f32_16x16x32_bf16 v[188:191], v[236:239], v[44:47], v[188:191]
    v_mfma_f32_16x16x32_bf16 v[192:195], v[236:239], v[48:51], v[192:195]
    v_mfma_f32_16x16x32_bf16 v[196:199], v[236:239], v[52:55], v[196:199]
    v_mfma_f32_16x16x32_bf16 v[200:203], v[236:239], v[56:59], v[200:203]
    v_mfma_f32_16x16x32_bf16 v[204:207], v[236:239], v[60:63], v[204:207]
    v_mfma_f32_16x16x32_bf16 v[208:211], v[236:239], v[64:67], v[208:211]
    v_mfma_f32_16x16x32_bf16 v[212:215], v[236:239], v[68:71], v[212:215]
    v_mfma_f32_16x16x32_bf16 v[216:219], v[236:239], v[72:75], v[216:219]
qkv_kernel_cw4:
    s_barrier
    s_waitcnt lgkmcnt(15)
    v_mfma_f32_16x16x32_bf16 v[220:223], v[236:239], v[32:35], v[220:223]
    ds_read_b128 v[24:27], v14 offset:0
    v_mfma_f32_16x16x32_bf16 v[228:231], v[32:35], v[32:35], v[228:231]
    ds_read_b128 v[28:31], v14 offset:2048
    s_waitcnt lgkmcnt(15)
    v_mfma_f32_16x16x32_bf16 v[224:227], v[236:239], v[36:39], v[224:227]
    ds_read_b64_tr_b16 v[40:41], v16 offset:0
    v_mfma_f32_16x16x32_bf16 v[232:235], v[36:39], v[36:39], v[232:235]
    ds_read_b64_tr_b16 v[42:43], v16 offset:2304
    s_waitcnt lgkmcnt(15)
    v_mfma_f32_16x16x32_bf16 v[112:115], v[32:35], v[76:79], v[112:115]
    ds_read_b64_tr_b16 v[44:45], v16 offset:32
    v_mfma_f32_16x16x32_bf16 v[148:151], v[36:39], v[76:79], v[148:151]
    ds_read_b64_tr_b16 v[46:47], v16 offset:2336
    v_mfma_f32_16x16x32_bf16 v[116:119], v[32:35], v[80:83], v[116:119]
    ds_read_b64_tr_b16 v[48:49], v16 offset:64
    v_mfma_f32_16x16x32_bf16 v[152:155], v[36:39], v[80:83], v[152:155]
    ds_read_b64_tr_b16 v[50:51], v16 offset:2368
    v_mfma_f32_16x16x32_bf16 v[120:123], v[32:35], v[84:87], v[120:123]
    ds_read_b64_tr_b16 v[52:53], v16 offset:96
    v_mfma_f32_16x16x32_bf16 v[156:159], v[36:39], v[84:87], v[156:159]
    ds_read_b64_tr_b16 v[54:55], v16 offset:2400
    s_waitcnt lgkmcnt(15)
    v_mfma_f32_16x16x32_bf16 v[124:127], v[32:35], v[88:91], v[124:127]
    ds_read_b64_tr_b16 v[56:57], v16 offset:128
    v_mfma_f32_16x16x32_bf16 v[160:163], v[36:39], v[88:91], v[160:163]
    ds_read_b64_tr_b16 v[58:59], v16 offset:2432
    v_mfma_f32_16x16x32_bf16 v[128:131], v[32:35], v[92:95], v[128:131]
    ds_read_b64_tr_b16 v[60:61], v16 offset:160
    v_mfma_f32_16x16x32_bf16 v[164:167], v[36:39], v[92:95], v[164:167]
    ds_read_b64_tr_b16 v[62:63], v16 offset:2464
    v_mfma_f32_16x16x32_bf16 v[132:135], v[32:35], v[96:99], v[132:135]
    ds_read_b64_tr_b16 v[64:65], v16 offset:192
    v_mfma_f32_16x16x32_bf16 v[168:171], v[36:39], v[96:99], v[168:171]
    ds_read_b64_tr_b16 v[66:67], v16 offset:2496
    s_waitcnt lgkmcnt(15)
    v_mfma_f32_16x16x32_bf16 v[136:139], v[32:35], v[100:103], v[136:139]
    ds_read_b64_tr_b16 v[68:69], v16 offset:224
    v_mfma_f32_16x16x32_bf16 v[172:175], v[36:39], v[100:103], v[172:175]
    ds_read_b64_tr_b16 v[70:71], v16 offset:2528
    v_mfma_f32_16x16x32_bf16 v[140:143], v[32:35], v[104:107], v[140:143]
    ds_read_b64_tr_b16 v[72:73], v16 offset:256
    v_mfma_f32_16x16x32_bf16 v[176:179], v[36:39], v[104:107], v[176:179]
    ds_read_b64_tr_b16 v[74:75], v16 offset:2560
    v_mfma_f32_16x16x32_bf16 v[144:147], v[32:35], v[108:111], v[144:147]
    v_mfma_f32_16x16x32_bf16 v[180:183], v[36:39], v[108:111], v[180:183]
    s_and_b32 s43, s42, 3
    s_add_u32 s42, s42, 1
    s_cmp_eq_u32 s43, s26
    s_cbranch_scc0 qkv_kernel_cw5
    v_mfma_f32_16x16x32_bf16 v[184:187], v[236:239], v[76:79], v[184:187]
    v_mfma_f32_16x16x32_bf16 v[188:191], v[236:239], v[80:83], v[188:191]
    v_mfma_f32_16x16x32_bf16 v[192:195], v[236:239], v[84:87], v[192:195]
    v_mfma_f32_16x16x32_bf16 v[196:199], v[236:239], v[88:91], v[196:199]
    v_mfma_f32_16x16x32_bf16 v[200:203], v[236:239], v[92:95], v[200:203]
    v_mfma_f32_16x16x32_bf16 v[204:207], v[236:239], v[96:99], v[204:207]
    v_mfma_f32_16x16x32_bf16 v[208:211], v[236:239], v[100:103], v[208:211]
    v_mfma_f32_16x16x32_bf16 v[212:215], v[236:239], v[104:107], v[212:215]
    v_mfma_f32_16x16x32_bf16 v[216:219], v[236:239], v[108:111], v[216:219]
qkv_kernel_cw5:
    s_add_u32 s40, s40, 1
    s_cmp_lt_u32 s40, 9
    s_cbranch_scc1 qkv_kernel_loop1
    s_waitcnt lgkmcnt(0)
    s_nop 7
    s_barrier
    s_mul_i32 s40, s26, 576
    v_lshlrev_b32 v24, 2, v3
    v_add_u32 v25, s40, v24
    ds_write_b32 v25, v184 offset:0
    ds_write_b32 v25, v188 offset:64
    ds_write_b32 v25, v192 offset:128
    ds_write_b32 v25, v196 offset:192
    ds_write_b32 v25, v200 offset:256
    ds_write_b32 v25, v204 offset:320
    ds_write_b32 v25, v208 offset:384
    ds_write_b32 v25, v212 offset:448
    ds_write_b32 v25, v216 offset:512
    v_and_b32 v26, 3, v3
    v_lshrrev_b32 v27, 2, v3
    v_lshl_add_u32 v27, v27, 4, v3
    v_lshlrev_b32 v27, 2, v27
    v_cmp_eq_u32 vcc, 1, v26
    s_nop 1
    v_cndmask_b32 v28, v228, v229, vcc
    v_cmp_eq_u32 vcc, 2, v26
    s_nop 1
    v_cndmask_b32 v28, v28, v230, vcc
    v_cmp_eq_u32 vcc, 3, v26
    s_nop 1
    v_cndmask_b32 v28, v28, v231, vcc
    ds_bpermute_b32 v30, v27, v28
    v_cmp_eq_u32 vcc, 1, v26
    s_nop 1
    v_cndmask_b32 v29, v232, v233, vcc
    v_cmp_eq_u32 vcc, 2, v26
    s_nop 1
    v_cndmask_b32 v29, v29, v234, vcc
    v_cmp_eq_u32 vcc, 3, v26
    s_nop 1
    v_cndmask_b32 v29, v29, v235, vcc
    ds_bpermute_b32 v31, v27, v29
    s_mov_b32 s44, 0x3ae38e39
    s_mov_b32 s45, 0x3727c5ac
    s_waitcnt lgkmcnt(0)
    v_mul_f32 v28, s44, v220
    v_mul_f32 v30, s44, v30
    v_fma_f32 v30, -v28, v28, v30
    v_max_f32 v30, 0, v30
    v_add_f32 v30, s45, v30
    v_rsq_f32 v32, v30
    v_mul_f32 v29, s44, v224
    v_mul_f32 v31, s44, v31
    v_fma_f32 v31, -v29, v29, v31
    v_max_f32 v31, 0, v31
    v_add_f32 v31, s45, v31
    v_rsq_f32 v33, v31
    s_nop 0
    v_mul_f32 v34, v28, v32
    v_mul_f32 v35, v29, v33
    s_barrier
    s_and_b32 s44, s25, 3
    s_lshl_b32 s44, s44, 3
    s_lshl_b32 s27, s24, 7
    s_lshl_b32 s30, s26, 5
    s_add_u32 s27, s27, s30
    s_mul_i32 s47, s26, 12288
    s_add_u32 s47, s47, 4096
    s_lshr_b32 s48, s27, 9
    s_mul_i32 s48, s48, 39936
    s_and_b32 s49, s27, 511
    s_mul_i32 s50, s44, 159744
    s_add_u32 s48, s48, s50
    ds_read_b32 v184, v24 offset:0
    ds_read_b32 v185, v24 offset:576
    ds_read_b32 v186, v24 offset:1152
    ds_read_b32 v187, v24 offset:1728
    ds_read_b32 v188, v24 offset:64
    ds_read_b32 v189, v24 offset:640
    ds_read_b32 v190, v24 offset:1216
    ds_read_b32 v191, v24 offset:1792
    ds_read_b32 v192, v24 offset:128
    ds_read_b32 v193, v24 offset:704
    ds_read_b32 v194, v24 offset:1280
    ds_read_b32 v195, v24 offset:1856
    ds_read_b32 v196, v24 offset:192
    ds_read_b32 v197, v24 offset:768
    ds_read_b32 v198, v24 offset:1344
    ds_read_b32 v199, v24 offset:1920
    ds_read_b32 v200, v24 offset:256
    ds_read_b32 v201, v24 offset:832
    ds_read_b32 v202, v24 offset:1408
    ds_read_b32 v203, v24 offset:1984
    ds_read_b32 v204, v24 offset:320
    ds_read_b32 v205, v24 offset:896
    ds_read_b32 v206, v24 offset:1472
    ds_read_b32 v207, v24 offset:2048
    ds_read_b32 v208, v24 offset:384
    ds_read_b32 v209, v24 offset:960
    ds_read_b32 v210, v24 offset:1536
    ds_read_b32 v211, v24 offset:2112
    ds_read_b32 v212, v24 offset:448
    ds_read_b32 v213, v24 offset:1024
    ds_read_b32 v214, v24 offset:1600
    ds_read_b32 v215, v24 offset:2176
    ds_read_b32 v216, v24 offset:512
    ds_read_b32 v217, v24 offset:1088
    ds_read_b32 v218, v24 offset:1664
    ds_read_b32 v219, v24 offset:2240
    s_waitcnt lgkmcnt(0)
    v_add_f32 v184, v184, v185
    v_add_f32 v186, v186, v187
    v_add_f32 v40, v184, v186
    v_add_f32 v188, v188, v189
    v_add_f32 v190, v190, v191
    v_add_f32 v41, v188, v190
    v_add_f32 v192, v192, v193
    v_add_f32 v194, v194, v195
    v_add_f32 v42, v192, v194
    v_add_f32 v196, v196, v197
    v_add_f32 v198, v198, v199
    v_add_f32 v43, v196, v198
    v_add_f32 v200, v200, v201
    v_add_f32 v202, v202, v203
    v_add_f32 v44, v200, v202
    v_add_f32 v204, v204, v205
    v_add_f32 v206, v206, v207
    v_add_f32 v45, v204, v206
    v_add_f32 v208, v208, v209
    v_add_f32 v210, v210, v211
    v_add_f32 v46, v208, v210
    v_add_f32 v212, v212, v213
    v_add_f32 v214, v214, v215
    v_add_f32 v47, v212, v214
    v_add_f32 v216, v216, v217
    v_add_f32 v218, v218, v219
    v_add_f32 v48, v216, v218
    s_lshl_b32 s45, s26, 8
    s_add_u32 s45, s45, 2304
    v_lshl_add_u32 v96, v3, 2, s45
    ds_write_b32 v96, v32 offset:0
    ds_write_b32 v96, v34 offset:128
    ds_write_b32 v96, v33 offset:64
    ds_write_b32 v96, v35 offset:192
    v_lshl_add_u32 v97, v2, 4, s45
    v_lshrrev_b32 v98, 2, v1
    v_mul_u32_u24 v98, 1216, v98
    v_and_b32 v99, 3, v1
    v_mul_u32_u24 v99, 304, v99
    v_add3_u32 v98, v98, v99, s47
    v_cmp_gt_u32 vcc, 32, v1
    s_and_saveexec_b64 s[52:53], vcc
    ds_write_b128 v98, v[236:239] offset:288
    s_mov_b64 exec, s[52:53]
    s_waitcnt lgkmcnt(0)
    ds_read_b128 v[52:55], v97 offset:0
    ds_read_b128 v[56:59], v97 offset:128
    ds_read_b128 v[60:63], v97 offset:64
    ds_read_b128 v[64:67], v97 offset:192
    v_and_b32 v98, 1, v2
    v_mul_u32_u24 v98, 304, v98
    v_lshrrev_b32 v99, 1, v2
    v_lshl_add_u32 v98, v99, 3, v98
    v_add_u32 v98, s47, v98
    s_waitcnt lgkmcnt(0)
    v_add_u32 v106, 0, v3
    v_mul_u32_u24 v107, 3641, v106
    v_lshrrev_b32 v107, 16, v107
    v_mul_u32_u24 v108, 18, v107
    v_sub_u32 v108, v106, v108
    v_mul_u32_u24 v107, 1216, v107
    v_lshl_add_u32 v107, v108, 4, v107
    v_add_u32 v107, v107, v98
    v_mul_f32 v100, v40, v56
    v_mul_f32 v101, v40, v57
    v_mul_f32 v102, v40, v58
    v_mul_f32 v103, v40, v59
    v_fma_f32 v100, v112, v52, -v100
    v_fma_f32 v101, v113, v53, -v101
    v_fma_f32 v102, v114, v54, -v102
    v_fma_f32 v103, v115, v55, -v103
    v_cvt_pk_bf16_f32 v112, v100, v101
    v_cvt_pk_bf16_f32 v113, v102, v103
    ds_write_b64 v107, v[112:113] offset:0
    v_mul_f32 v100, v40, v64
    v_mul_f32 v101, v40, v65
    v_mul_f32 v102, v40, v66
    v_mul_f32 v103, v40, v67
    v_fma_f32 v100, v148, v60, -v100
    v_fma_f32 v101, v149, v61, -v101
    v_fma_f32 v102, v150, v62, -v102
    v_fma_f32 v103, v151, v63, -v103
    v_cvt_pk_bf16_f32 v148, v100, v101
    v_cvt_pk_bf16_f32 v149, v102, v103
    ds_write_b64 v107, v[148:149] offset:608
    v_add_u32 v106, 16, v3
    v_mul_u32_u24 v107, 3641, v106
    v_lshrrev_b32 v107, 16, v107
    v_mul_u32_u24 v108, 18, v107
    v_sub_u32 v108, v106, v108
    v_mul_u32_u24 v107, 1216, v107
    v_lshl_add_u32 v107, v108, 4, v107
    v_add_u32 v107, v107, v98
    v_mul_f32 v100, v41, v56
    v_mul_f32 v101, v41, v57
    v_mul_f32 v102, v41, v58
    v_mul_f32 v103, v41, v59
    v_fma_f32 v100, v116, v52, -v100
    v_fma_f32 v101, v117, v53, -v101
    v_fma_f32 v102, v118, v54, -v102
    v_fma_f32 v103, v119, v55, -v103
    v_cvt_pk_bf16_f32 v116, v100, v101
    v_cvt_pk_bf16_f32 v117, v102, v103
    ds_write_b64 v107, v[116:117] offset:0
    v_mul_f32 v100, v41, v64
    v_mul_f32 v101, v41, v65
    v_mul_f32 v102, v41, v66
    v_mul_f32 v103, v41, v67
    v_fma_f32 v100, v152, v60, -v100
    v_fma_f32 v101, v153, v61, -v101
    v_fma_f32 v102, v154, v62, -v102
    v_fma_f32 v103, v155, v63, -v103
    v_cvt_pk_bf16_f32 v152, v100, v101
    v_cvt_pk_bf16_f32 v153, v102, v103
    ds_write_b64 v107, v[152:153] offset:608
    v_add_u32 v106, 32, v3
    v_mul_u32_u24 v107, 3641, v106
    v_lshrrev_b32 v107, 16, v107
    v_mul_u32_u24 v108, 18, v107
    v_sub_u32 v108, v106, v108
    v_mul_u32_u24 v107, 1216, v107
    v_lshl_add_u32 v107, v108, 4, v107
    v_add_u32 v107, v107, v98
    v_mul_f32 v100, v42, v56
    v_mul_f32 v101, v42, v57
    v_mul_f32 v102, v42, v58
    v_mul_f32 v103, v42, v59
    v_fma_f32 v100, v120, v52, -v100
    v_fma_f32 v101, v121, v53, -v101
    v_fma_f32 v102, v122, v54, -v102
    v_fma_f32 v103, v123, v55, -v103
    v_cvt_pk_bf16_f32 v120, v100, v101
    v_cvt_pk_bf16_f32 v121, v102, v103
    ds_write_b64 v107, v[120:121] offset:0
    v_mul_f32 v100, v42, v64
    v_mul_f32 v101, v42, v65
    v_mul_f32 v102, v42, v66
    v_mul_f32 v103, v42, v67
    v_fma_f32 v100, v156, v60, -v100
    v_fma_f32 v101, v157, v61, -v101
    v_fma_f32 v102, v158, v62, -v102
    v_fma_f32 v103, v159, v63, -v103
    v_cvt_pk_bf16_f32 v156, v100, v101
    v_cvt_pk_bf16_f32 v157, v102, v103
    ds_write_b64 v107, v[156:157] offset:608
    v_add_u32 v106, 48, v3
    v_mul_u32_u24 v107, 3641, v106
    v_lshrrev_b32 v107, 16, v107
    v_mul_u32_u24 v108, 18, v107
    v_sub_u32 v108, v106, v108
    v_mul_u32_u24 v107, 1216, v107
    v_lshl_add_u32 v107, v108, 4, v107
    v_add_u32 v107, v107, v98
    v_mul_f32 v100, v43, v56
    v_mul_f32 v101, v43, v57
    v_mul_f32 v102, v43, v58
    v_mul_f32 v103, v43, v59
    v_fma_f32 v100, v124, v52, -v100
    v_fma_f32 v101, v125, v53, -v101
    v_fma_f32 v102, v126, v54, -v102
    v_fma_f32 v103, v127, v55, -v103
    v_cvt_pk_bf16_f32 v124, v100, v101
    v_cvt_pk_bf16_f32 v125, v102, v103
    ds_write_b64 v107, v[124:125] offset:0
    v_mul_f32 v100, v43, v64
    v_mul_f32 v101, v43, v65
    v_mul_f32 v102, v43, v66
    v_mul_f32 v103, v43, v67
    v_fma_f32 v100, v160, v60, -v100
    v_fma_f32 v101, v161, v61, -v101
    v_fma_f32 v102, v162, v62, -v102
    v_fma_f32 v103, v163, v63, -v103
    v_cvt_pk_bf16_f32 v160, v100, v101
    v_cvt_pk_bf16_f32 v161, v102, v103
    ds_write_b64 v107, v[160:161] offset:608
    v_add_u32 v106, 64, v3
    v_mul_u32_u24 v107, 3641, v106
    v_lshrrev_b32 v107, 16, v107
    v_mul_u32_u24 v108, 18, v107
    v_sub_u32 v108, v106, v108
    v_mul_u32_u24 v107, 1216, v107
    v_lshl_add_u32 v107, v108, 4, v107
    v_add_u32 v107, v107, v98
    v_mul_f32 v100, v44, v56
    v_mul_f32 v101, v44, v57
    v_mul_f32 v102, v44, v58
    v_mul_f32 v103, v44, v59
    v_fma_f32 v100, v128, v52, -v100
    v_fma_f32 v101, v129, v53, -v101
    v_fma_f32 v102, v130, v54, -v102
    v_fma_f32 v103, v131, v55, -v103
    v_cvt_pk_bf16_f32 v128, v100, v101
    v_cvt_pk_bf16_f32 v129, v102, v103
    ds_write_b64 v107, v[128:129] offset:0
    v_mul_f32 v100, v44, v64
    v_mul_f32 v101, v44, v65
    v_mul_f32 v102, v44, v66
    v_mul_f32 v103, v44, v67
    v_fma_f32 v100, v164, v60, -v100
    v_fma_f32 v101, v165, v61, -v101
    v_fma_f32 v102, v166, v62, -v102
    v_fma_f32 v103, v167, v63, -v103
    v_cvt_pk_bf16_f32 v164, v100, v101
    v_cvt_pk_bf16_f32 v165, v102, v103
    ds_write_b64 v107, v[164:165] offset:608
    v_add_u32 v106, 80, v3
    v_mul_u32_u24 v107, 3641, v106
    v_lshrrev_b32 v107, 16, v107
    v_mul_u32_u24 v108, 18, v107
    v_sub_u32 v108, v106, v108
    v_mul_u32_u24 v107, 1216, v107
    v_lshl_add_u32 v107, v108, 4, v107
    v_add_u32 v107, v107, v98
    v_mul_f32 v100, v45, v56
    v_mul_f32 v101, v45, v57
    v_mul_f32 v102, v45, v58
    v_mul_f32 v103, v45, v59
    v_fma_f32 v100, v132, v52, -v100
    v_fma_f32 v101, v133, v53, -v101
    v_fma_f32 v102, v134, v54, -v102
    v_fma_f32 v103, v135, v55, -v103
    v_cvt_pk_bf16_f32 v132, v100, v101
    v_cvt_pk_bf16_f32 v133, v102, v103
    ds_write_b64 v107, v[132:133] offset:0
    v_mul_f32 v100, v45, v64
    v_mul_f32 v101, v45, v65
    v_mul_f32 v102, v45, v66
    v_mul_f32 v103, v45, v67
    v_fma_f32 v100, v168, v60, -v100
    v_fma_f32 v101, v169, v61, -v101
    v_fma_f32 v102, v170, v62, -v102
    v_fma_f32 v103, v171, v63, -v103
    v_cvt_pk_bf16_f32 v168, v100, v101
    v_cvt_pk_bf16_f32 v169, v102, v103
    ds_write_b64 v107, v[168:169] offset:608
    v_add_u32 v106, 96, v3
    v_mul_u32_u24 v107, 3641, v106
    v_lshrrev_b32 v107, 16, v107
    v_mul_u32_u24 v108, 18, v107
    v_sub_u32 v108, v106, v108
    v_mul_u32_u24 v107, 1216, v107
    v_lshl_add_u32 v107, v108, 4, v107
    v_add_u32 v107, v107, v98
    v_mul_f32 v100, v46, v56
    v_mul_f32 v101, v46, v57
    v_mul_f32 v102, v46, v58
    v_mul_f32 v103, v46, v59
    v_fma_f32 v100, v136, v52, -v100
    v_fma_f32 v101, v137, v53, -v101
    v_fma_f32 v102, v138, v54, -v102
    v_fma_f32 v103, v139, v55, -v103
    v_cvt_pk_bf16_f32 v136, v100, v101
    v_cvt_pk_bf16_f32 v137, v102, v103
    ds_write_b64 v107, v[136:137] offset:0
    v_mul_f32 v100, v46, v64
    v_mul_f32 v101, v46, v65
    v_mul_f32 v102, v46, v66
    v_mul_f32 v103, v46, v67
    v_fma_f32 v100, v172, v60, -v100
    v_fma_f32 v101, v173, v61, -v101
    v_fma_f32 v102, v174, v62, -v102
    v_fma_f32 v103, v175, v63, -v103
    v_cvt_pk_bf16_f32 v172, v100, v101
    v_cvt_pk_bf16_f32 v173, v102, v103
    ds_write_b64 v107, v[172:173] offset:608
    v_add_u32 v106, 112, v3
    v_mul_u32_u24 v107, 3641, v106
    v_lshrrev_b32 v107, 16, v107
    v_mul_u32_u24 v108, 18, v107
    v_sub_u32 v108, v106, v108
    v_mul_u32_u24 v107, 1216, v107
    v_lshl_add_u32 v107, v108, 4, v107
    v_add_u32 v107, v107, v98
    v_mul_f32 v100, v47, v56
    v_mul_f32 v101, v47, v57
    v_mul_f32 v102, v47, v58
    v_mul_f32 v103, v47, v59
    v_fma_f32 v100, v140, v52, -v100
    v_fma_f32 v101, v141, v53, -v101
    v_fma_f32 v102, v142, v54, -v102
    v_fma_f32 v103, v143, v55, -v103
    v_cvt_pk_bf16_f32 v140, v100, v101
    v_cvt_pk_bf16_f32 v141, v102, v103
    ds_write_b64 v107, v[140:141] offset:0
    v_mul_f32 v100, v47, v64
    v_mul_f32 v101, v47, v65
    v_mul_f32 v102, v47, v66
    v_mul_f32 v103, v47, v67
    v_fma_f32 v100, v176, v60, -v100
    v_fma_f32 v101, v177, v61, -v101
    v_fma_f32 v102, v178, v62, -v102
    v_fma_f32 v103, v179, v63, -v103
    v_cvt_pk_bf16_f32 v176, v100, v101
    v_cvt_pk_bf16_f32 v177, v102, v103
    ds_write_b64 v107, v[176:177] offset:608
    v_add_u32 v106, 128, v3
    v_mul_u32_u24 v107, 3641, v106
    v_lshrrev_b32 v107, 16, v107
    v_mul_u32_u24 v108, 18, v107
    v_sub_u32 v108, v106, v108
    v_mul_u32_u24 v107, 1216, v107
    v_lshl_add_u32 v107, v108, 4, v107
    v_add_u32 v107, v107, v98
    v_mul_f32 v100, v48, v56
    v_mul_f32 v101, v48, v57
    v_mul_f32 v102, v48, v58
    v_mul_f32 v103, v48, v59
    v_fma_f32 v100, v144, v52, -v100
    v_fma_f32 v101, v145, v53, -v101
    v_fma_f32 v102, v146, v54, -v102
    v_fma_f32 v103, v147, v55, -v103
    v_cvt_pk_bf16_f32 v144, v100, v101
    v_cvt_pk_bf16_f32 v145, v102, v103
    ds_write_b64 v107, v[144:145] offset:0
    v_mul_f32 v100, v48, v64
    v_mul_f32 v101, v48, v65
    v_mul_f32 v102, v48, v66
    v_mul_f32 v103, v48, v67
    v_fma_f32 v100, v180, v60, -v100
    v_fma_f32 v101, v181, v61, -v101
    v_fma_f32 v102, v182, v62, -v102
    v_fma_f32 v103, v183, v63, -v103
    v_cvt_pk_bf16_f32 v180, v100, v101
    v_cvt_pk_bf16_f32 v181, v102, v103
    ds_write_b64 v107, v[180:181] offset:608
    v_lshl_add_u32 v96, v1, 4, s47
    s_waitcnt lgkmcnt(0)
    ds_read_b128 v[40:43], v96 offset:0
    ds_read_b128 v[44:47], v96 offset:1024
    ds_read_b128 v[48:51], v96 offset:2048
    ds_read_b128 v[52:55], v96 offset:3072
    ds_read_b128 v[56:59], v96 offset:4096
    ds_read_b128 v[60:63], v96 offset:5120
    ds_read_b128 v[64:67], v96 offset:6144
    ds_read_b128 v[68:71], v96 offset:7168
    ds_read_b128 v[72:75], v96 offset:8192
    ds_read_b128 v[76:79], v96 offset:9216
    s_lshr_b32 s50, s49, 4
    s_mul_i32 s50, s50, 608
    s_add_u32 s50, s50, s48
    s_add_u32 s50, s50, 20480
    s_mov_b32 s51, 158528
    v_add_u32 v100, 0, v1
    v_mul_u32_u24 v101, 863, v100
    v_lshrrev_b32 v101, 16, v101
    v_mul_lo_u32 v101, v101, s51
    v_lshl_add_u32 v84, v100, 4, v101
    v_add_u32 v100, 64, v1
    v_mul_u32_u24 v101, 863, v100
    v_lshrrev_b32 v101, 16, v101
    v_mul_lo_u32 v101, v101, s51
    v_lshl_add_u32 v85, v100, 4, v101
    v_add_u32 v100, 128, v1
    v_mul_u32_u24 v101, 863, v100
    v_lshrrev_b32 v101, 16, v101
    v_mul_lo_u32 v101, v101, s51
    v_lshl_add_u32 v86, v100, 4, v101
    v_add_u32 v100, 192, v1
    v_mul_u32_u24 v101, 863, v100
    v_lshrrev_b32 v101, 16, v101
    v_mul_lo_u32 v101, v101, s51
    v_lshl_add_u32 v87, v100, 4, v101
    v_add_u32 v100, 256, v1
    v_mul_u32_u24 v101, 863, v100
    v_lshrrev_b32 v101, 16, v101
    v_mul_lo_u32 v101, v101, s51
    v_lshl_add_u32 v88, v100, 4, v101
    v_add_u32 v100, 320, v1
    v_mul_u32_u24 v101, 863, v100
    v_lshrrev_b32 v101, 16, v101
    v_mul_lo_u32 v101, v101, s51
    v_lshl_add_u32 v89, v100, 4, v101
    v_add_u32 v100, 384, v1
    v_mul_u32_u24 v101, 863, v100
    v_lshrrev_b32 v101, 16, v101
    v_mul_lo_u32 v101, v101, s51
    v_lshl_add_u32 v90, v100, 4, v101
    v_add_u32 v100, 448, v1
    v_mul_u32_u24 v101, 863, v100
    v_lshrrev_b32 v101, 16, v101
    v_mul_lo_u32 v101, v101, s51
    v_lshl_add_u32 v91, v100, 4, v101
    v_add_u32 v100, 512, v1
    v_mul_u32_u24 v101, 863, v100
    v_lshrrev_b32 v101, 16, v101
    v_mul_lo_u32 v101, v101, s51
    v_lshl_add_u32 v92, v100, 4, v101
    v_add_u32 v100, 576, v1
    v_mul_u32_u24 v101, 863, v100
    v_lshrrev_b32 v101, 16, v101
    v_mul_lo_u32 v101, v101, s51
    v_lshl_add_u32 v93, v100, 4, v101
    s_waitcnt lgkmcnt(0)
    buffer_store_dwordx4 v[40:43], v84, s[20:23], s50 offen
    buffer_store_dwordx4 v[44:47], v85, s[20:23], s50 offen
    buffer_store_dwordx4 v[48:51], v86, s[20:23], s50 offen
    buffer_store_dwordx4 v[52:55], v87, s[20:23], s50 offen
    buffer_store_dwordx4 v[56:59], v88, s[20:23], s50 offen
    buffer_store_dwordx4 v[60:63], v89, s[20:23], s50 offen
    buffer_store_dwordx4 v[64:67], v90, s[20:23], s50 offen
    buffer_store_dwordx4 v[68:71], v91, s[20:23], s50 offen
    buffer_store_dwordx4 v[72:75], v92, s[20:23], s50 offen
    s_and_saveexec_b64 s[52:53], vcc
    buffer_store_dwordx4 v[76:79], v93, s[20:23], s50 offen
    s_mov_b64 exec, s[52:53]
qkv_kernel_done:
qkv_kernel_end:
    s_endpgm

.globl attn_kernel
.p2align 8
.type attn_kernel,@function
attn_kernel:
    s_cmp_ge_u32 s2, 256
    s_cbranch_scc1 attn_kernel_end
    s_load_dwordx2 s[28:29], s[0:1], 80
    s_load_dwordx2 s[4:5], s[0:1], 32
    s_load_dwordx2 s[6:7], s[0:1], 48
    s_load_dwordx2 s[64:65], s[0:1], 16
    s_and_b32 s24, s2, 7
    s_lshl_b32 s24, s24, 2
    s_lshr_b32 s25, s2, 3
    s_and_b32 s25, s25, 3
    s_add_u32 s24, s24, s25
    s_lshr_b32 s25, s2, 5
    v_and_b32 v1, 63, v0
    v_lshrrev_b32 v2, 5, v1
    v_and_b32 v3, 31, v1
    v_lshrrev_b32 v4, 6, v0
    s_nop 1
    v_readfirstlane_b32 s26, v4
    s_waitcnt lgkmcnt(0)
    s_add_u32 s8, s28, 0
    s_addc_u32 s9, s29, 0
    s_mov_b32 s10, 3145728
    s_mov_b32 s11, 0x00020000
    s_add_u32 s12, s28, 3145728
    s_addc_u32 s13, s29, 0
    s_mov_b32 s14, 5120000
    s_mov_b32 s15, 0x00020000
    s_add_u32 s16, s28, 8388608
    s_addc_u32 s17, s29, 0
    s_mov_b32 s18, 2359296
    s_mov_b32 s19, 0x00020000
    s_mov_b32 s44, s4
    s_mov_b32 s45, s5
    s_mov_b32 s46, 18874368
    s_mov_b32 s47, 0x00020000
    s_mov_b32 s48, s6
    s_mov_b32 s49, s7
    s_mov_b32 s50, 18874368
    s_mov_b32 s51, 0x00020000
    s_mov_b32 s76, s64
    s_mov_b32 s77, s65
    s_mov_b32 s78, 663552
    s_mov_b32 s79, 0x00020000
    s_cmp_ge_u32 s26, 8
    s_cbranch_scc0 attn_kernel_nopf
    s_and_b32 s52, s2, 7
    s_lshr_b32 s53, s2, 3
    s_mul_i32 s53, s53, 576
    s_sub_u32 s54, s26, 8
    s_mul_i32 s54, s54, 144
    s_add_u32 s53, s53, s54
    s_lshr_b32 s56, s52, 1
    s_mul_i32 s56, s56, 4718592
    s_and_b32 s57, s52, 1
    s_lshl_b32 s57, s57, 11
    s_add_u32 s56, s56, s57
    s_mul_i32 s57, s52, 1152
    s_mul_i32 s30, s24, 159744
    s_sub_u32 s31, s26, 8
    s_lshl_b32 s31, s31, 10
    s_add_u32 s31, s31, 40960
    s_add_u32 s30, s30, s31
    v_lshl_add_u32 v4, v1, 4, s30
    s_barrier
    s_add_u32 m0, s31, 0
    s_mov_b32 s32, 0
    buffer_load_dwordx4 v4, s[12:15], s32 offen lds
    s_add_u32 m0, s31, 4096
    s_mov_b32 s32, 4096
    buffer_load_dwordx4 v4, s[12:15], s32 offen lds
    s_add_u32 m0, s31, 8192
    s_mov_b32 s32, 8192
    buffer_load_dwordx4 v4, s[12:15], s32 offen lds
    s_add_u32 m0, s31, 12288
    s_mov_b32 s32, 12288
    buffer_load_dwordx4 v4, s[12:15], s32 offen lds
    s_add_u32 m0, s31, 16384
    s_mov_b32 s32, 16384
    buffer_load_dwordx4 v4, s[12:15], s32 offen lds
    s_add_u32 m0, s31, 20480
    s_mov_b32 s32, 20480
    buffer_load_dwordx4 v4, s[12:15], s32 offen lds
    s_add_u32 m0, s31, 24576
    s_mov_b32 s32, 24576
    buffer_load_dwordx4 v4, s[12:15], s32 offen lds
    s_add_u32 m0, s31, 28672
    s_mov_b32 s32, 28672
    buffer_load_dwordx4 v4, s[12:15], s32 offen lds
    s_add_u32 m0, s31, 32768
    s_mov_b32 s32, 32768
    buffer_load_dwordx4 v4, s[12:15], s32 offen lds
    s_add_u32 m0, s31, 36864
    s_mov_b32 s32, 36864
    buffer_load_dwordx4 v4, s[12:15], s32 offen lds
    s_add_u32 m0, s31, 40960
    s_mov_b32 s32, 40960
    buffer_load_dwordx4 v4, s[12:15], s32 offen lds
    s_add_u32 m0, s31, 45056
    s_mov_b32 s32, 45056
    buffer_load_dwordx4 v4, s[12:15], s32 offen lds
    s_add_u32 m0, s31, 49152
    s_mov_b32 s32, 49152
    buffer_load_dwordx4 v4, s[12:15], s32 offen lds
    s_add_u32 m0, s31, 53248
    s_mov_b32 s32, 53248
    buffer_load_dwordx4 v4, s[12:15], s32 offen lds
    s_add_u32 m0, s31, 57344
    s_mov_b32 s32, 57344
    buffer_load_dwordx4 v4, s[12:15], s32 offen lds
    s_add_u32 m0, s31, 61440
    s_mov_b32 s32, 61440
    buffer_load_dwordx4 v4, s[12:15], s32 offen lds
    s_add_u32 m0, s31, 65536
    s_mov_b32 s32, 65536
    buffer_load_dwordx4 v4, s[12:15], s32 offen lds
    s_add_u32 m0, s31, 69632
    s_mov_b32 s32, 69632
    buffer_load_dwordx4 v4, s[12:15], s32 offen lds
    s_add_u32 m0, s31, 73728
    s_mov_b32 s32, 73728
    buffer_load_dwordx4 v4, s[12:15], s32 offen lds
    s_add_u32 m0, s31, 77824
    s_mov_b32 s32, 77824
    buffer_load_dwordx4 v4, s[12:15], s32 offen lds
    s_add_u32 m0, s31, 81920
    s_mov_b32 s32, 81920
    buffer_load_dwordx4 v4, s[12:15], s32 offen lds
    s_add_u32 m0, s31, 86016
    s_mov_b32 s32, 86016
    buffer_load_dwordx4 v4, s[12:15], s32 offen lds
    s_add_u32 m0, s31, 90112
    s_mov_b32 s32, 90112
    buffer_load_dwordx4 v4, s[12:15], s32 offen lds
    s_add_u32 m0, s31, 94208
    s_mov_b32 s32, 94208
    buffer_load_dwordx4 v4, s[12:15], s32 offen lds
    s_add_u32 m0, s31, 98304
    s_mov_b32 s32, 98304
    buffer_load_dwordx4 v4, s[12:15], s32 offen lds
    s_add_u32 m0, s31, 102400
    s_mov_b32 s32, 102400
    buffer_load_dwordx4 v4, s[12:15], s32 offen lds
    s_add_u32 m0, s31, 106496
    s_mov_b32 s32, 106496
    buffer_load_dwordx4 v4, s[12:15], s32 offen lds
    s_add_u32 m0, s31, 110592
    s_mov_b32 s32, 110592
    buffer_load_dwordx4 v4, s[12:15], s32 offen lds
    s_add_u32 m0, s31, 114688
    s_mov_b32 s32, 114688
    buffer_load_dwordx4 v4, s[12:15], s32 offen lds
    s_add_u32 m0, s31, 118784
    s_mov_b32 s32, 118784
    buffer_load_dwordx4 v4, s[12:15], s32 offen lds
    s_waitcnt vmcnt(0)
    s_barrier
    s_mov_b32 exec_hi, 0xffff
    s_lshr_b32 s58, s2, 3
    s_lshl_b32 s58, s58, 2
    s_add_u32 s58, s58, s26
    s_sub_u32 s58, s58, 8
    s_mul_i32 s58, s58, 41
    v_add_u32 v5, s58, v1
    v_lshlrev_b32 v6, 7, v5
    buffer_load_dword v10, v6, s[76:79], 0 offen
    s_lshr_b32 s58, s2, 3
    s_lshl_b32 s58, s58, 2
    s_add_u32 s58, s58, s26
    s_sub_u32 s58, s58, 8
    s_mul_i32 s59, s58, 144
    v_add_u32 v20, s59, v1
    v_mul_u32_u24 v21, 58255, v20
    v_lshrrev_b32 v21, 19, v21
    v_mul_u32_u24 v22, 9, v21
    v_sub_u32 v22, v20, v22
    v_mul_u32_u24 v21, 9216, v21
    v_lshl_add_u32 v21, v22, 7, v21
    buffer_load_dword v23, v21, s[44:47], s57 offen
    v_add_u32 v20, s59, v1
    v_add_u32 v20, 48, v20
    v_mul_u32_u24 v21, 58255, v20
    v_lshrrev_b32 v21, 19, v21
    v_mul_u32_u24 v22, 9, v21
    v_sub_u32 v22, v20, v22
    v_mul_u32_u24 v21, 9216, v21
    v_lshl_add_u32 v21, v22, 7, v21
    buffer_load_dword v23, v21, s[44:47], s57 offen
    v_add_u32 v20, s59, v1
    v_add_u32 v20, 96, v20
    v_mul_u32_u24 v21, 58255, v20
    v_lshrrev_b32 v21, 19, v21
    v_mul_u32_u24 v22, 9, v21
    v_sub_u32 v22, v20, v22
    v_mul_u32_u24 v21, 9216, v21
    v_lshl_add_u32 v21, v22, 7, v21
    buffer_load_dword v23, v21, s[44:47], s57 offen
    s_mul_i32 s59, s58, 144
    v_add_u32 v5, s59, v1
    v_lshrrev_b32 v6, 4, v5
    v_lshlrev_b32 v6, 12, v6
    v_and_b32 v7, 15, v5
    v_lshl_add_u32 v6, v7, 7, v6
    buffer_load_dword v9, v6, s[48:51], s56 offen
    v_add_u32 v5, s59, v1
    v_add_u32 v5, 48, v5
    v_lshrrev_b32 v6, 4, v5
    v_lshlrev_b32 v6, 12, v6
    v_and_b32 v7, 15, v5
    v_lshl_add_u32 v6, v7, 7, v6
    buffer_load_dword v9, v6, s[48:51], s56 offen
    v_add_u32 v5, s59, v1
    v_add_u32 v5, 96, v5
    v_lshrrev_b32 v6, 4, v5
    v_lshlrev_b32 v6, 12, v6
    v_and_b32 v7, 15, v5
    v_lshl_add_u32 v6, v7, 7, v6
    buffer_load_dword v9, v6, s[48:51], s56 offen
    s_endpgm
attn_kernel_nopf:
    s_lshl_b32 s27, s25, 8
    s_lshl_b32 s30, s26, 5
    s_add_u32 s27, s27, s30
    s_lshl_b32 s30, s24, 11
    s_add_u32 s30, s30, s27
    v_add_u32 v128, s30, v3
    v_mul_u32_u24 v128, 48, v128
    v_lshl_add_u32 v129, v2, 4, v128
    buffer_load_dwordx4 v[8:11], v129, s[8:11], 0 offen
    buffer_load_dword v12, v128, s[8:11], 0 offen offset:32
    s_mul_i32 s30, s24, 159744
    s_lshl_b32 s31, s26, 10
    s_add_u32 s30, s30, s31
    v_lshl_add_u32 v4, v1, 4, s30
    s_add_u32 m0, s31, 0
    s_mov_b32 s32, 0
    buffer_load_dwordx4 v4, s[12:15], s32 offen lds
    s_add_u32 m0, s31, 8192
    s_mov_b32 s32, 8192
    buffer_load_dwordx4 v4, s[12:15], s32 offen lds
    s_add_u32 m0, s31, 16384
    s_mov_b32 s32, 16384
    buffer_load_dwordx4 v4, s[12:15], s32 offen lds
    s_add_u32 m0, s31, 24576
    s_mov_b32 s32, 24576
    buffer_load_dwordx4 v4, s[12:15], s32 offen lds
    s_add_u32 m0, s31, 32768
    s_mov_b32 s32, 32768
    buffer_load_dwordx4 v4, s[12:15], s32 offen lds
    v_lshlrev_b32 v5, 4, v1
    v_lshlrev_b32 v6, 3, v3
    v_add_u32 v6, 16384, v6
    v_min_u32 v7, 18, v3
    v_lshlrev_b32 v7, 4, v7
    v_mul_u32_u24 v130, 304, v2
    v_add_u32 v7, v7, v130
    v_add_u32 v7, 20480, v7
    v_mov_b32 v131, v5
    v_mov_b32 v132, v6
    v_mov_b32 v133, v7
    v_mov_b32 v22, 0
    v_mov_b32 v23, 0
    v_mov_b32 v30, 0
    v_mov_b32 v31, 0
    v_mov_b32 v32, 0
    v_mov_b32 v33, 0
    v_mov_b32 v34, 0
    v_mov_b32 v35, 0
    v_mov_b32 v36, 0
    v_mov_b32 v37, 0
    v_mov_b32 v38, 0
    v_mov_b32 v39, 0
    v_mov_b32 v40, 0
    v_mov_b32 v41, 0
    v_mov_b32 v42, 0
    v_mov_b32 v43, 0
    v_mov_b32 v44, 0
    v_mov_b32 v45, 0
    v_mov_b32 v46, 0
    v_mov_b32 v47, 0
    v_mov_b32 v80, 0
    v_mov_b32 v81, 0
    v_mov_b32 v82, 0
    v_mov_b32 v83, 0
    v_mov_b32 v84, 0
    v_mov_b32 v85, 0
    v_mov_b32 v86, 0
    v_mov_b32 v87, 0
    v_mov_b32 v88, 0
    v_mov_b32 v89, 0
    v_mov_b32 v90, 0
    v_mov_b32 v91, 0
    v_mov_b32 v92, 0
    v_mov_b32 v93, 0
    v_mov_b32 v94, 0
    v_mov_b32 v95, 0
    v_mov_b32 v112, 0
    v_mov_b32 v113, 0
    v_mov_b32 v114, 0
    v_mov_b32 v115, 0
    v_mov_b32 v116, 0
    v_mov_b32 v117, 0
    v_mov_b32 v118, 0
    v_mov_b32 v119, 0
    v_mov_b32 v120, 0
    v_mov_b32 v121, 0
    v_mov_b32 v122, 0
    v_mov_b32 v123, 0
    v_mov_b32 v124, 0
    v_mov_b32 v125, 0
    v_mov_b32 v126, 0
    v_mov_b32 v127, 0
    v_mov_b32 v13, 0
    v_mov_b32 v14, 0
    v_mov_b32 v15, 0
    v_cmp_gt_u32 s[34:35], 32, v1
    s_waitcnt vmcnt(0)
    v_cndmask_b32 v12, 0, v12, s[34:35]
    s_barrier
    ds_read_b128 v[16:19], v5 offset:0
    ds_read_b64 v[20:21], v6 offset:0
    ds_read_b128 v[24:27], v5 offset:1024
    ds_read_b64 v[28:29], v6 offset:256
    s_waitcnt lgkmcnt(0)
    v_mfma_f32_32x32x16_bf16 v[48:63], v[16:19], v[8:11], 0
    v_mfma_f32_32x32x16_bf16 v[48:63], v[20:23], v[12:15], v[48:63]
    s_nop 7
    s_nop 7
    v_max_f32 v134, v48, v49
    v_max_f32 v134, v134, v50
    v_max_f32 v134, v134, v51
    v_max_f32 v134, v134, v52
    v_max_f32 v134, v134, v53
    v_max_f32 v134, v134, v54
    v_max_f32 v134, v134, v55
    v_max_f32 v134, v134, v56
    v_max_f32 v134, v134, v57
    v_max_f32 v134, v134, v58
    v_max_f32 v134, v134, v59
    v_max_f32 v134, v134, v60
    v_max_f32 v134, v134, v61
    v_max_f32 v134, v134, v62
    v_max_f32 v134, v134, v63
    v_mov_b32 v135, v134
    s_nop 1
    v_permlane32_swap_b32 v134, v135
    s_nop 1
    v_max_f32 v134, v134, v135
    v_sub_f32 v134, 0, v134
    v_cvt_pk_bf16_f32 v134, v134, 0
    s_nop 0
    v_cndmask_b32 v13, 0, v134, s[34:35]
    s_nop 1
    v_mfma_f32_32x32x16_bf16 v[48:63], v[16:19], v[8:11], 0
    v_mfma_f32_32x32x16_bf16 v[48:63], v[20:23], v[12:15], v[48:63]
    s_mov_b32 s33, 0
    s_nop 7
    s_nop 3
attn_kernel_loop:
    s_waitcnt lgkmcnt(0)
    v_mfma_f32_32x32x16_bf16 v[64:79], v[24:27], v[8:11], 0
    ds_read_b128 v[16:19], v5 offset:2048
    ds_read_b64 v[20:21], v6 offset:512
    v_exp_f32 v96, v48
    v_exp_f32 v97, v49
    v_exp_f32 v98, v50
    v_exp_f32 v99, v51
    ds_read_b128 v[32:35], v7 offset:0
    v_mfma_f32_32x32x16_bf16 v[64:79], v[28:31], v[12:15], v[64:79]
    ds_read_b128 v[36:39], v7 offset:608
    v_exp_f32 v100, v52
    v_exp_f32 v101, v53
    v_exp_f32 v102, v54
    v_exp_f32 v103, v55
    v_cvt_pk_bf16_f32 v80, v96, v97
    v_cvt_pk_bf16_f32 v81, v98, v99
    v_mfma_f32_32x32x16_bf16 v[112:127], v[40:43], v[88:91], v[112:127]
    v_exp_f32 v104, v56
    v_exp_f32 v105, v57
    v_exp_f32 v106, v58
    v_exp_f32 v107, v59
    v_cvt_pk_bf16_f32 v82, v100, v101
    v_cvt_pk_bf16_f32 v83, v102, v103
    v_mfma_f32_32x32x16_bf16 v[112:127], v[44:47], v[92:95], v[112:127]
    v_exp_f32 v108, v60
    v_exp_f32 v109, v61
    v_exp_f32 v110, v62
    v_exp_f32 v111, v63
    v_cvt_pk_bf16_f32 v84, v104, v105
    v_cvt_pk_bf16_f32 v85, v106, v107
    v_cvt_pk_bf16_f32 v86, v108, v109
    v_cvt_pk_bf16_f32 v87, v110, v111
    s_waitcnt lgkmcnt(0)
    v_mfma_f32_32x32x16_bf16 v[48:63], v[16:19], v[8:11], 0
    ds_read_b128 v[24:27], v5 offset:3072
    ds_read_b64 v[28:29], v6 offset:768
    v_exp_f32 v96, v64
    v_exp_f32 v97, v65
    v_exp_f32 v98, v66
    v_exp_f32 v99, v67
    ds_read_b128 v[40:43], v7 offset:1216
    v_mfma_f32_32x32x16_bf16 v[48:63], v[20:23], v[12:15], v[48:63]
    ds_read_b128 v[44:47], v7 offset:1824
    v_exp_f32 v100, v68
    v_exp_f32 v101, v69
    v_exp_f32 v102, v70
    v_exp_f32 v103, v71
    v_cvt_pk_bf16_f32 v88, v96, v97
    v_cvt_pk_bf16_f32 v89, v98, v99
    v_mfma_f32_32x32x16_bf16 v[112:127], v[32:35], v[80:83], v[112:127]
    v_exp_f32 v104, v72
    v_exp_f32 v105, v73
    v_exp_f32 v106, v74
    v_exp_f32 v107, v75
    v_cvt_pk_bf16_f32 v90, v100, v101
    v_cvt_pk_bf16_f32 v91, v102, v103
    v_mfma_f32_32x32x16_bf16 v[112:127], v[36:39], v[84:87], v[112:127]
    v_exp_f32 v108, v76
    v_exp_f32 v109, v77
    v_exp_f32 v110, v78
    v_exp_f32 v111, v79
    v_cvt_pk_bf16_f32 v92, v104, v105
    v_cvt_pk_bf16_f32 v93, v106, v107
    v_cvt_pk_bf16_f32 v94, v108, v109
    v_cvt_pk_bf16_f32 v95, v110, v111
    s_waitcnt lgkmcnt(0)
    v_mfma_f32_32x32x16_bf16 v[64:79], v[24:27], v[8:11], 0
    ds_read_b128 v[16:19], v5 offset:4096
    ds_read_b64 v[20:21], v6 offset:1024
    v_exp_f32 v96, v48
    v_exp_f32 v97, v49
    v_exp_f32 v98, v50
    v_exp_f32 v99, v51
    ds_read_b128 v[32:35], v7 offset:2432
    v_mfma_f32_32x32x16_bf16 v[64:79], v[28:31], v[12:15], v[64:79]
    ds_read_b128 v[36:39], v7 offset:3040
    v_exp_f32 v100, v52
    v_exp_f32 v101, v53
    v_exp_f32 v102, v54
    v_exp_f32 v103, v55
    v_cvt_pk_bf16_f32 v80, v96, v97
    v_cvt_pk_bf16_f32 v81, v98, v99
    v_mfma_f32_32x32x16_bf16 v[112:127], v[40:43], v[88:91], v[112:127]
    v_exp_f32 v104, v56
    v_exp_f32 v105, v57
    v_exp_f32 v106, v58
    v_exp_f32 v107, v59
    v_cvt_pk_bf16_f32 v82, v100, v101
    v_cvt_pk_bf16_f32 v83, v102, v103
    v_mfma_f32_32x32x16_bf16 v[112:127], v[44:47], v[92:95], v[112:127]
    v_exp_f32 v108, v60
    v_exp_f32 v109, v61
    v_exp_f32 v110, v62
    v_exp_f32 v111, v63
    v_cvt_pk_bf16_f32 v84, v104, v105
    v_cvt_pk_bf16_f32 v85, v106, v107
    v_cvt_pk_bf16_f32 v86, v108, v109
    v_cvt_pk_bf16_f32 v87, v110, v111
    s_waitcnt lgkmcnt(0)
    v_mfma_f32_32x32x16_bf16 v[48:63], v[16:19], v[8:11], 0
    ds_read_b128 v[24:27], v5 offset:5120
    ds_read_b64 v[28:29], v6 offset:1280
    v_exp_f32 v96, v64
    v_exp_f32 v97, v65
    v_exp_f32 v98, v66
    v_exp_f32 v99, v67
    ds_read_b128 v[40:43], v7 offset:3648
    v_mfma_f32_32x32x16_bf16 v[48:63], v[20:23], v[12:15], v[48:63]
    ds_read_b128 v[44:47], v7 offset:4256
    v_exp_f32 v100, v68
    v_exp_f32 v101, v69
    v_exp_f32 v102, v70
    v_exp_f32 v103, v71
    v_cvt_pk_bf16_f32 v88, v96, v97
    v_cvt_pk_bf16_f32 v89, v98, v99
    v_mfma_f32_32x32x16_bf16 v[112:127], v[32:35], v[80:83], v[112:127]
    v_exp_f32 v104, v72
    v_exp_f32 v105, v73
    v_exp_f32 v106, v74
    v_exp_f32 v107, v75
    v_cvt_pk_bf16_f32 v90, v100, v101
    v_cvt_pk_bf16_f32 v91, v102, v103
    v_mfma_f32_32x32x16_bf16 v[112:127], v[36:39], v[84:87], v[112:127]
    v_exp_f32 v108, v76
    v_exp_f32 v109, v77
    v_exp_f32 v110, v78
    v_exp_f32 v111, v79
    v_cvt_pk_bf16_f32 v92, v104, v105
    v_cvt_pk_bf16_f32 v93, v106, v107
    v_cvt_pk_bf16_f32 v94, v108, v109
    v_cvt_pk_bf16_f32 v95, v110, v111
    s_waitcnt lgkmcnt(0)
    v_mfma_f32_32x32x16_bf16 v[64:79], v[24:27], v[8:11], 0
    ds_read_b128 v[16:19], v5 offset:6144
    ds_read_b64 v[20:21], v6 offset:1536
    v_exp_f32 v96, v48
    v_exp_f32 v97, v49
    v_exp_f32 v98, v50
    v_exp_f32 v99, v51
    ds_read_b128 v[32:35], v7 offset:4864
    v_mfma_f32_32x32x16_bf16 v[64:79], v[28:31], v[12:15], v[64:79]
    ds_read_b128 v[36:39], v7 offset:5472
    v_exp_f32 v100, v52
    v_exp_f32 v101, v53
    v_exp_f32 v102, v54
    v_exp_f32 v103, v55
    v_cvt_pk_bf16_f32 v80, v96, v97
    v_cvt_pk_bf16_f32 v81, v98, v99
    v_mfma_f32_32x32x16_bf16 v[112:127], v[40:43], v[88:91], v[112:127]
    v_exp_f32 v104, v56
    v_exp_f32 v105, v57
    v_exp_f32 v106, v58
    v_exp_f32 v107, v59
    v_cvt_pk_bf16_f32 v82, v100, v101
    v_cvt_pk_bf16_f32 v83, v102, v103
    v_mfma_f32_32x32x16_bf16 v[112:127], v[44:47], v[92:95], v[112:127]
    v_exp_f32 v108, v60
    v_exp_f32 v109, v61
    v_exp_f32 v110, v62
    v_exp_f32 v111, v63
    v_cvt_pk_bf16_f32 v84, v104, v105
    v_cvt_pk_bf16_f32 v85, v106, v107
    v_cvt_pk_bf16_f32 v86, v108, v109
    v_cvt_pk_bf16_f32 v87, v110, v111
    s_waitcnt lgkmcnt(0)
    v_mfma_f32_32x32x16_bf16 v[48:63], v[16:19], v[8:11], 0
    ds_read_b128 v[24:27], v5 offset:7168
    ds_read_b64 v[28:29], v6 offset:1792
    v_exp_f32 v96, v64
    v_exp_f32 v97, v65
    v_exp_f32 v98, v66
    v_exp_f32 v99, v67
    ds_read_b128 v[40:43], v7 offset:6080
    v_mfma_f32_32x32x16_bf16 v[48:63], v[20:23], v[12:15], v[48:63]
    ds_read_b128 v[44:47], v7 offset:6688
    v_exp_f32 v100, v68
    v_exp_f32 v101, v69
    v_exp_f32 v102, v70
    v_exp_f32 v103, v71
    v_cvt_pk_bf16_f32 v88, v96, v97
    v_cvt_pk_bf16_f32 v89, v98, v99
    v_mfma_f32_32x32x16_bf16 v[112:127], v[32:35], v[80:83], v[112:127]
    v_exp_f32 v104, v72
    v_exp_f32 v105, v73
    v_exp_f32 v106, v74
    v_exp_f32 v107, v75
    v_cvt_pk_bf16_f32 v90, v100, v101
    v_cvt_pk_bf16_f32 v91, v102, v103
    v_mfma_f32_32x32x16_bf16 v[112:127], v[36:39], v[84:87], v[112:127]
    v_exp_f32 v108, v76
    v_exp_f32 v109, v77
    v_exp_f32 v110, v78
    v_exp_f32 v111, v79
    v_cvt_pk_bf16_f32 v92, v104, v105
    v_cvt_pk_bf16_f32 v93, v106, v107
    v_cvt_pk_bf16_f32 v94, v108, v109
    v_cvt_pk_bf16_f32 v95, v110, v111
    s_waitcnt lgkmcnt(0)
    v_mfma_f32_32x32x16_bf16 v[64:79], v[24:27], v[8:11], 0
    ds_read_b128 v[16:19], v5 offset:8192
    ds_read_b64 v[20:21], v6 offset:2048
    v_exp_f32 v96, v48
    v_exp_f32 v97, v49
    v_exp_f32 v98, v50
    v_exp_f32 v99, v51
    ds_read_b128 v[32:35], v7 offset:7296
    v_mfma_f32_32x32x16_bf16 v[64:79], v[28:31], v[12:15], v[64:79]
    ds_read_b128 v[36:39], v7 offset:7904
    v_exp_f32 v100, v52
    v_exp_f32 v101, v53
    v_exp_f32 v102, v54
    v_exp_f32 v103, v55
    v_cvt_pk_bf16_f32 v80, v96, v97
    v_cvt_pk_bf16_f32 v81, v98, v99
    v_mfma_f32_32x32x16_bf16 v[112:127], v[40:43], v[88:91], v[112:127]
    v_exp_f32 v104, v56
    v_exp_f32 v105, v57
    v_exp_f32 v106, v58
    v_exp_f32 v107, v59
    v_cvt_pk_bf16_f32 v82, v100, v101
    v_cvt_pk_bf16_f32 v83, v102, v103
    v_mfma_f32_32x32x16_bf16 v[112:127], v[44:47], v[92:95], v[112:127]
    v_exp_f32 v108, v60
    v_exp_f32 v109, v61
    v_exp_f32 v110, v62
    v_exp_f32 v111, v63
    v_cvt_pk_bf16_f32 v84, v104, v105
    v_cvt_pk_bf16_f32 v85, v106, v107
    v_cvt_pk_bf16_f32 v86, v108, v109
    v_cvt_pk_bf16_f32 v87, v110, v111
    s_waitcnt lgkmcnt(0)
    v_mfma_f32_32x32x16_bf16 v[48:63], v[16:19], v[8:11], 0
    ds_read_b128 v[24:27], v5 offset:9216
    ds_read_b64 v[28:29], v6 offset:2304
    v_exp_f32 v96, v64
    v_exp_f32 v97, v65
    v_exp_f32 v98, v66
    v_exp_f32 v99, v67
    ds_read_b128 v[40:43], v7 offset:8512
    v_mfma_f32_32x32x16_bf16 v[48:63], v[20:23], v[12:15], v[48:63]
    ds_read_b128 v[44:47], v7 offset:9120
    v_exp_f32 v100, v68
    v_exp_f32 v101, v69
    v_exp_f32 v102, v70
    v_exp_f32 v103, v71
    v_cvt_pk_bf16_f32 v88, v96, v97
    v_cvt_pk_bf16_f32 v89, v98, v99
    v_mfma_f32_32x32x16_bf16 v[112:127], v[32:35], v[80:83], v[112:127]
    v_exp_f32 v104, v72
    v_exp_f32 v105, v73
    v_exp_f32 v106, v74
    v_exp_f32 v107, v75
    v_cvt_pk_bf16_f32 v90, v100, v101
    v_cvt_pk_bf16_f32 v91, v102, v103
    v_mfma_f32_32x32x16_bf16 v[112:127], v[36:39], v[84:87], v[112:127]
    v_exp_f32 v108, v76
    v_exp_f32 v109, v77
    v_exp_f32 v110, v78
    v_exp_f32 v111, v79
    v_cvt_pk_bf16_f32 v92, v104, v105
    v_cvt_pk_bf16_f32 v93, v106, v107
    v_cvt_pk_bf16_f32 v94, v108, v109
    v_cvt_pk_bf16_f32 v95, v110, v111
    s_waitcnt lgkmcnt(0)
    v_mfma_f32_32x32x16_bf16 v[64:79], v[24:27], v[8:11], 0
    ds_read_b128 v[16:19], v5 offset:10240
    ds_read_b64 v[20:21], v6 offset:2560
    v_exp_f32 v96, v48
    v_exp_f32 v97, v49
    v_exp_f32 v98, v50
    v_exp_f32 v99, v51
    ds_read_b128 v[32:35], v7 offset:9728
    v_mfma_f32_32x32x16_bf16 v[64:79], v[28:31], v[12:15], v[64:79]
    ds_read_b128 v[36:39], v7 offset:10336
    v_exp_f32 v100, v52
    v_exp_f32 v101, v53
    v_exp_f32 v102, v54
    v_exp_f32 v103, v55
    v_cvt_pk_bf16_f32 v80, v96, v97
    v_cvt_pk_bf16_f32 v81, v98, v99
    v_mfma_f32_32x32x16_bf16 v[112:127], v[40:43], v[88:91], v[112:127]
    v_exp_f32 v104, v56
    v_exp_f32 v105, v57
    v_exp_f32 v106, v58
    v_exp_f32 v107, v59
    v_cvt_pk_bf16_f32 v82, v100, v101
    v_cvt_pk_bf16_f32 v83, v102, v103
    v_mfma_f32_32x32x16_bf16 v[112:127], v[44:47], v[92:95], v[112:127]
    v_exp_f32 v108, v60
    v_exp_f32 v109, v61
    v_exp_f32 v110, v62
    v_exp_f32 v111, v63
    v_cvt_pk_bf16_f32 v84, v104, v105
    v_cvt_pk_bf16_f32 v85, v106, v107
    v_cvt_pk_bf16_f32 v86, v108, v109
    v_cvt_pk_bf16_f32 v87, v110, v111
    s_waitcnt lgkmcnt(0)
    v_mfma_f32_32x32x16_bf16 v[48:63], v[16:19], v[8:11], 0
    ds_read_b128 v[24:27], v5 offset:11264
    ds_read_b64 v[28:29], v6 offset:2816
    v_exp_f32 v96, v64
    v_exp_f32 v97, v65
    v_exp_f32 v98, v66
    v_exp_f32 v99, v67
    ds_read_b128 v[40:43], v7 offset:10944
    v_mfma_f32_32x32x16_bf16 v[48:63], v[20:23], v[12:15], v[48:63]
    ds_read_b128 v[44:47], v7 offset:11552
    v_exp_f32 v100, v68
    v_exp_f32 v101, v69
    v_exp_f32 v102, v70
    v_exp_f32 v103, v71
    v_cvt_pk_bf16_f32 v88, v96, v97
    v_cvt_pk_bf16_f32 v89, v98, v99
    v_mfma_f32_32x32x16_bf16 v[112:127], v[32:35], v[80:83], v[112:127]
    v_exp_f32 v104, v72
    v_exp_f32 v105, v73
    v_exp_f32 v106, v74
    v_exp_f32 v107, v75
    v_cvt_pk_bf16_f32 v90, v100, v101
    v_cvt_pk_bf16_f32 v91, v102, v103
    v_mfma_f32_32x32x16_bf16 v[112:127], v[36:39], v[84:87], v[112:127]
    v_exp_f32 v108, v76
    v_exp_f32 v109, v77
    v_exp_f32 v110, v78
    v_exp_f32 v111, v79
    v_cvt_pk_bf16_f32 v92, v104, v105
    v_cvt_pk_bf16_f32 v93, v106, v107
    v_cvt_pk_bf16_f32 v94, v108, v109
    v_cvt_pk_bf16_f32 v95, v110, v111
    s_waitcnt lgkmcnt(0)
    v_mfma_f32_32x32x16_bf16 v[64:79], v[24:27], v[8:11], 0
    ds_read_b128 v[16:19], v5 offset:12288
    ds_read_b64 v[20:21], v6 offset:3072
    v_exp_f32 v96, v48
    v_exp_f32 v97, v49
    v_exp_f32 v98, v50
    v_exp_f32 v99, v51
    ds_read_b128 v[32:35], v7 offset:12160
    v_mfma_f32_32x32x16_bf16 v[64:79], v[28:31], v[12:15], v[64:79]
    ds_read_b128 v[36:39], v7 offset:12768
    v_exp_f32 v100, v52
    v_exp_f32 v101, v53
    v_exp_f32 v102, v54
    v_exp_f32 v103, v55
    v_cvt_pk_bf16_f32 v80, v96, v97
    v_cvt_pk_bf16_f32 v81, v98, v99
    v_mfma_f32_32x32x16_bf16 v[112:127], v[40:43], v[88:91], v[112:127]
    v_exp_f32 v104, v56
    v_exp_f32 v105, v57
    v_exp_f32 v106, v58
    v_exp_f32 v107, v59
    v_cvt_pk_bf16_f32 v82, v100, v101
    v_cvt_pk_bf16_f32 v83, v102, v103
    v_mfma_f32_32x32x16_bf16 v[112:127], v[44:47], v[92:95], v[112:127]
    v_exp_f32 v108, v60
    v_exp_f32 v109, v61
    v_exp_f32 v110, v62
    v_exp_f32 v111, v63
    v_cvt_pk_bf16_f32 v84, v104, v105
    v_cvt_pk_bf16_f32 v85, v106, v107
    v_cvt_pk_bf16_f32 v86, v108, v109
    v_cvt_pk_bf16_f32 v87, v110, v111
    s_waitcnt lgkmcnt(0)
    v_mfma_f32_32x32x16_bf16 v[48:63], v[16:19], v[8:11], 0
    ds_read_b128 v[24:27], v5 offset:13312
    ds_read_b64 v[28:29], v6 offset:3328
    v_exp_f32 v96, v64
    v_exp_f32 v97, v65
    v_exp_f32 v98, v66
    v_exp_f32 v99, v67
    ds_read_b128 v[40:43], v7 offset:13376
    v_mfma_f32_32x32x16_bf16 v[48:63], v[20:23], v[12:15], v[48:63]
    ds_read_b128 v[44:47], v7 offset:13984
    v_exp_f32 v100, v68
    v_exp_f32 v101, v69
    v_exp_f32 v102, v70
    v_exp_f32 v103, v71
    v_cvt_pk_bf16_f32 v88, v96, v97
    v_cvt_pk_bf16_f32 v89, v98, v99
    v_mfma_f32_32x32x16_bf16 v[112:127], v[32:35], v[80:83], v[112:127]
    v_exp_f32 v104, v72
    v_exp_f32 v105, v73
    v_exp_f32 v106, v74
    v_exp_f32 v107, v75
    v_cvt_pk_bf16_f32 v90, v100, v101
    v_cvt_pk_bf16_f32 v91, v102, v103
    v_mfma_f32_32x32x16_bf16 v[112:127], v[36:39], v[84:87], v[112:127]
    v_exp_f32 v108, v76
    v_exp_f32 v109, v77
    v_exp_f32 v110, v78
    v_exp_f32 v111, v79
    v_cvt_pk_bf16_f32 v92, v104, v105
    v_cvt_pk_bf16_f32 v93, v106, v107
    v_cvt_pk_bf16_f32 v94, v108, v109
    v_cvt_pk_bf16_f32 v95, v110, v111
    s_waitcnt lgkmcnt(0)
    v_mfma_f32_32x32x16_bf16 v[64:79], v[24:27], v[8:11], 0
    ds_read_b128 v[16:19], v5 offset:14336
    ds_read_b64 v[20:21], v6 offset:3584
    v_exp_f32 v96, v48
    v_exp_f32 v97, v49
    v_exp_f32 v98, v50
    v_exp_f32 v99, v51
    ds_read_b128 v[32:35], v7 offset:14592
    v_mfma_f32_32x32x16_bf16 v[64:79], v[28:31], v[12:15], v[64:79]
    ds_read_b128 v[36:39], v7 offset:15200
    v_exp_f32 v100, v52
    v_exp_f32 v101, v53
    v_exp_f32 v102, v54
    v_exp_f32 v103, v55
    v_cvt_pk_bf16_f32 v80, v96, v97
    v_cvt_pk_bf16_f32 v81, v98, v99
    v_mfma_f32_32x32x16_bf16 v[112:127], v[40:43], v[88:91], v[112:127]
    v_exp_f32 v104, v56
    v_exp_f32 v105, v57
    v_exp_f32 v106, v58
    v_exp_f32 v107, v59
    v_cvt_pk_bf16_f32 v82, v100, v101
    v_cvt_pk_bf16_f32 v83, v102, v103
    v_mfma_f32_32x32x16_bf16 v[112:127], v[44:47], v[92:95], v[112:127]
    v_exp_f32 v108, v60
    v_exp_f32 v109, v61
    v_exp_f32 v110, v62
    v_exp_f32 v111, v63
    v_cvt_pk_bf16_f32 v84, v104, v105
    v_cvt_pk_bf16_f32 v85, v106, v107
    v_cvt_pk_bf16_f32 v86, v108, v109
    v_cvt_pk_bf16_f32 v87, v110, v111
    s_waitcnt lgkmcnt(0)
    v_mfma_f32_32x32x16_bf16 v[48:63], v[16:19], v[8:11], 0
    ds_read_b128 v[24:27], v5 offset:15360
    ds_read_b64 v[28:29], v6 offset:3840
    v_exp_f32 v96, v64
    v_exp_f32 v97, v65
    v_exp_f32 v98, v66
    v_exp_f32 v99, v67
    ds_read_b128 v[40:43], v7 offset:15808
    v_mfma_f32_32x32x16_bf16 v[48:63], v[20:23], v[12:15], v[48:63]
    ds_read_b128 v[44:47], v7 offset:16416
    v_exp_f32 v100, v68
    v_exp_f32 v101, v69
    v_exp_f32 v102, v70
    v_exp_f32 v103, v71
    v_cvt_pk_bf16_f32 v88, v96, v97
    v_cvt_pk_bf16_f32 v89, v98, v99
    v_mfma_f32_32x32x16_bf16 v[112:127], v[32:35], v[80:83], v[112:127]
    v_exp_f32 v104, v72
    v_exp_f32 v105, v73
    v_exp_f32 v106, v74
    v_exp_f32 v107, v75
    v_cvt_pk_bf16_f32 v90, v100, v101
    v_cvt_pk_bf16_f32 v91, v102, v103
    v_mfma_f32_32x32x16_bf16 v[112:127], v[36:39], v[84:87], v[112:127]
    v_exp_f32 v108, v76
    v_exp_f32 v109, v77
    v_exp_f32 v110, v78
    v_exp_f32 v111, v79
    v_cvt_pk_bf16_f32 v92, v104, v105
    v_cvt_pk_bf16_f32 v93, v106, v107
    v_cvt_pk_bf16_f32 v94, v108, v109
    v_cvt_pk_bf16_f32 v95, v110, v111
    s_cmp_eq_u32 s33, 0
    s_cbranch_scc0 attn_kernel_nb1
    s_waitcnt vmcnt(0)
    s_barrier
attn_kernel_nb1:
    s_waitcnt lgkmcnt(0)
    v_mfma_f32_32x32x16_bf16 v[64:79], v[24:27], v[8:11], 0
    ds_read_b128 v[16:19], v5 offset:39936
    ds_read_b64 v[20:21], v6 offset:39936
    v_exp_f32 v96, v48
    v_exp_f32 v97, v49
    v_exp_f32 v98, v50
    v_exp_f32 v99, v51
    ds_read_b128 v[32:35], v7 offset:17024
    v_mfma_f32_32x32x16_bf16 v[64:79], v[28:31], v[12:15], v[64:79]
    ds_read_b128 v[36:39], v7 offset:17632
    v_exp_f32 v100, v52
    v_exp_f32 v101, v53
    v_exp_f32 v102, v54
    v_exp_f32 v103, v55
    v_cvt_pk_bf16_f32 v80, v96, v97
    v_cvt_pk_bf16_f32 v81, v98, v99
    v_mfma_f32_32x32x16_bf16 v[112:127], v[40:43], v[88:91], v[112:127]
    v_exp_f32 v104, v56
    v_exp_f32 v105, v57
    v_exp_f32 v106, v58
    v_exp_f32 v107, v59
    v_cvt_pk_bf16_f32 v82, v100, v101
    v_cvt_pk_bf16_f32 v83, v102, v103
    v_mfma_f32_32x32x16_bf16 v[112:127], v[44:47], v[92:95], v[112:127]
    v_exp_f32 v108, v60
    v_exp_f32 v109, v61
    v_exp_f32 v110, v62
    v_exp_f32 v111, v63
    v_cvt_pk_bf16_f32 v84, v104, v105
    v_cvt_pk_bf16_f32 v85, v106, v107
    v_cvt_pk_bf16_f32 v86, v108, v109
    v_cvt_pk_bf16_f32 v87, v110, v111
    s_waitcnt lgkmcnt(0)
    v_mfma_f32_32x32x16_bf16 v[48:63], v[16:19], v[8:11], 0
    ds_read_b128 v[24:27], v5 offset:40960
    ds_read_b64 v[28:29], v6 offset:40192
    v_exp_f32 v96, v64
    v_exp_f32 v97, v65
    v_exp_f32 v98, v66
    v_exp_f32 v99, v67
    ds_read_b128 v[40:43], v7 offset:18240
    v_mfma_f32_32x32x16_bf16 v[48:63], v[20:23], v[12:15], v[48:63]
    ds_read_b128 v[44:47], v7 offset:18848
    v_exp_f32 v100, v68
    v_exp_f32 v101, v69
    v_exp_f32 v102, v70
    v_exp_f32 v103, v71
    v_cvt_pk_bf16_f32 v88, v96, v97
    v_cvt_pk_bf16_f32 v89, v98, v99
    v_mfma_f32_32x32x16_bf16 v[112:127], v[32:35], v[80:83], v[112:127]
    v_exp_f32 v104, v72
    v_exp_f32 v105, v73
    v_exp_f32 v106, v74
    v_exp_f32 v107, v75
    v_cvt_pk_bf16_f32 v90, v100, v101
    v_cvt_pk_bf16_f32 v91, v102, v103
    v_mfma_f32_32x32x16_bf16 v[112:127], v[36:39], v[84:87], v[112:127]
    v_exp_f32 v108, v76
    v_exp_f32 v109, v77
    v_exp_f32 v110, v78
    v_exp_f32 v111, v79
    v_cvt_pk_bf16_f32 v92, v104, v105
    v_cvt_pk_bf16_f32 v93, v106, v107
    v_cvt_pk_bf16_f32 v94, v108, v109
    v_cvt_pk_bf16_f32 v95, v110, v111
    v_add_u32 v5, 39936, v5
    v_add_u32 v6, 39936, v6
    v_add_u32 v7, 39936, v7
    s_add_u32 s33, s33, 1
    s_cmp_lt_u32 s33, 4
    s_cbranch_scc1 attn_kernel_loop
    s_waitcnt lgkmcnt(0)
    v_mfma_f32_32x32x16_bf16 v[112:127], v[40:43], v[88:91], v[112:127]
    v_mfma_f32_32x32x16_bf16 v[112:127], v[44:47], v[92:95], v[112:127]
attn_kernel_fin:
    s_nop 7
    s_nop 7
    v_mov_b32 v134, v122
    v_mov_b32 v135, v122
    s_nop 1
    v_permlane32_swap_b32 v134, v135
    s_mov_b32 s36, 0x53800000
    s_nop 0
    v_cmp_ngt_f32 vcc, s36, v134
    s_cmp_eq_u32 s33, 99
    s_cbranch_scc1 attn_kernel_store
    s_cbranch_vccnz attn_kernel_slow
attn_kernel_store:
    v_rcp_f32 v134, v134
    s_nop 0
    v_mul_f32 v112, v112, v134
    v_mul_f32 v113, v113, v134
    v_mul_f32 v114, v114, v134
    v_mul_f32 v115, v115, v134
    v_mul_f32 v116, v116, v134
    v_mul_f32 v117, v117, v134
    v_mul_f32 v118, v118, v134
    v_mul_f32 v119, v119, v134
    v_mul_f32 v120, v120, v134
    v_mul_f32 v121, v121, v134
    v_cvt_pk_bf16_f32 v96, v112, v113
    v_cvt_pk_bf16_f32 v97, v114, v115
    v_cvt_pk_bf16_f32 v98, v116, v117
    v_cvt_pk_bf16_f32 v99, v118, v119
    v_cvt_pk_bf16_f32 v100, v120, v121
    v_add_u32 v128, s27, v3
    v_mul_u32_u24 v128, 1152, v128
    v_lshl_add_u32 v128, v2, 3, v128
    s_mul_i32 s30, s24, 36
    buffer_store_dwordx2 v[96:97], v128, s[16:19], s30 offen
    buffer_store_dwordx2 v[98:99], v128, s[16:19], s30 offen offset:16
    s_and_saveexec_b64 s[38:39], s[34:35]
    buffer_store_dword v100, v128, s[16:19], s30 offen offset:32
    s_endpgm
attn_kernel_slow:
    v_mov_b32 v5, v131
    v_mov_b32 v6, v132
    v_mov_b32 v7, v133
    v_mov_b32 v13, 0
    v_mov_b32 v112, 0
    v_mov_b32 v113, 0
    v_mov_b32 v114, 0
    v_mov_b32 v115, 0
    v_mov_b32 v116, 0
    v_mov_b32 v117, 0
    v_mov_b32 v118, 0
    v_mov_b32 v119, 0
    v_mov_b32 v120, 0
    v_mov_b32 v121, 0
    v_mov_b32 v122, 0
    v_mov_b32 v123, 0
    v_mov_b32 v124, 0
    v_mov_b32 v125, 0
    v_mov_b32 v126, 0
    v_mov_b32 v127, 0
    v_mov_b32 v136, 0xff800000
    s_mov_b32 s33, 0
attn_kernel_sl1:
    s_mov_b32 s37, 0
attn_kernel_sl2:
    ds_read_b128 v[16:19], v5 offset:0
    ds_read_b64 v[20:21], v6 offset:0
    ds_read_b128 v[32:35], v7 offset:0
    ds_read_b128 v[36:39], v7 offset:608
    s_waitcnt lgkmcnt(0)
    v_mfma_f32_32x32x16_bf16 v[48:63], v[16:19], v[8:11], 0
    v_mfma_f32_32x32x16_bf16 v[48:63], v[20:23], v[12:15], v[48:63]
    s_nop 7
    s_nop 7
    v_max_f32 v134, v48, v49
    v_max_f32 v134, v134, v50
    v_max_f32 v134, v134, v51
    v_max_f32 v134, v134, v52
    v_max_f32 v134, v134, v53
    v_max_f32 v134, v134, v54
    v_max_f32 v134, v134, v55
    v_max_f32 v134, v134, v56
    v_max_f32 v134, v134, v57
    v_max_f32 v134, v134, v58
    v_max_f32 v134, v134, v59
    v_max_f32 v134, v134, v60
    v_max_f32 v134, v134, v61
    v_max_f32 v134, v134, v62
    v_max_f32 v134, v134, v63
    v_mov_b32 v135, v134
    s_nop 1
    v_permlane32_swap_b32 v134, v135
    s_nop 1
    v_max_f32 v134, v134, v135
    v_max_f32 v134, v134, v136
    v_sub_f32 v135, v136, v134
    v_exp_f32 v135, v135
    v_mov_b32 v136, v134
    v_sub_f32 v96, v48, v134
    v_sub_f32 v97, v49, v134
    v_sub_f32 v98, v50, v134
    v_sub_f32 v99, v51, v134
    v_sub_f32 v100, v52, v134
    v_sub_f32 v101, v53, v134
    v_sub_f32 v102, v54, v134
    v_sub_f32 v103, v55, v134
    v_sub_f32 v104, v56, v134
    v_sub_f32 v105, v57, v134
    v_sub_f32 v106, v58, v134
    v_sub_f32 v107, v59, v134
    v_sub_f32 v108, v60, v134
    v_sub_f32 v109, v61, v134
    v_sub_f32 v110, v62, v134
    v_sub_f32 v111, v63, v134
    v_exp_f32 v96, v96
    v_exp_f32 v97, v97
    v_exp_f32 v98, v98
    v_exp_f32 v99, v99
    v_exp_f32 v100, v100
    v_exp_f32 v101, v101
    v_exp_f32 v102, v102
    v_exp_f32 v103, v103
    v_exp_f32 v104, v104
    v_exp_f32 v105, v105
    v_exp_f32 v106, v106
    v_exp_f32 v107, v107
    v_exp_f32 v108, v108
    v_exp_f32 v109, v109
    v_exp_f32 v110, v110
    v_exp_f32 v111, v111
    v_mul_f32 v112, v112, v135
    v_mul_f32 v113, v113, v135
    v_mul_f32 v114, v114, v135
    v_mul_f32 v115, v115, v135
    v_mul_f32 v116, v116, v135
    v_mul_f32 v117, v117, v135
    v_mul_f32 v118, v118, v135
    v_mul_f32 v119, v119, v135
    v_mul_f32 v120, v120, v135
    v_mul_f32 v121, v121, v135
    v_mul_f32 v122, v122, v135
    v_mul_f32 v123, v123, v135
    v_mul_f32 v124, v124, v135
    v_mul_f32 v125, v125, v135
    v_mul_f32 v126, v126, v135
    v_mul_f32 v127, v127, v135
    v_cvt_pk_bf16_f32 v80, v96, v97
    v_cvt_pk_bf16_f32 v81, v98, v99
    v_cvt_pk_bf16_f32 v82, v100, v101
    v_cvt_pk_bf16_f32 v83, v102, v103
    v_cvt_pk_bf16_f32 v84, v104, v105
    v_cvt_pk_bf16_f32 v85, v106, v107
    v_cvt_pk_bf16_f32 v86, v108, v109
    v_cvt_pk_bf16_f32 v87, v110, v111
    s_nop 1
    v_mfma_f32_32x32x16_bf16 v[112:127], v[32:35], v[80:83], v[112:127]
    v_mfma_f32_32x32x16_bf16 v[112:127], v[36:39], v[84:87], v[112:127]
    s_nop 7
    s_nop 7
    v_add_u32 v5, 1024, v5
    v_add_u32 v6, 256, v6
    v_add_u32 v7, 1216, v7
    s_add_u32 s37, s37, 1
    s_cmp_lt_u32 s37, 16
    s_cbranch_scc1 attn_kernel_sl2
    v_add_u32 v5, 23552, v5
    v_add_u32 v6, 35840, v6
    v_add_u32 v7, 20480, v7
    s_add_u32 s33, s33, 1
    s_cmp_lt_u32 s33, 4
    s_cbranch_scc1 attn_kernel_sl1
    s_mov_b32 s33, 99
    s_branch attn_kernel_fin
attn_kernel_end:
    s_endpgm

.globl oproj_kernel
.p2align 8
.type oproj_kernel,@function
oproj_kernel:
    s_cmp_ge_u32 s2, 192
    s_cbranch_scc1 oproj_kernel_end
    s_load_dwordx2 s[4:5], s[0:1], 0
    s_load_dwordx2 s[6:7], s[0:1], 16
    s_load_dwordx2 s[28:29], s[0:1], 80
    v_and_b32 v1, 63, v0
    v_lshrrev_b32 v2, 4, v1
    v_and_b32 v3, 15, v1
    v_lshrrev_b32 v4, 6, v0
    s_nop 1
    v_readfirstlane_b32 s26, v4
    s_and_b32 s24, s2, 7
    s_mul_i32 s24, s24, 24
    s_lshr_b32 s25, s2, 3
    s_add_u32 s24, s24, s25
    s_mul_i32 s25, s24, 10923
    s_lshr_b32 s25, s25, 16
    s_mul_i32 s30, s25, 6
    s_sub_u32 s24, s24, s30
    s_waitcnt lgkmcnt(0)
    s_mov_b32 s8, s4
    s_mov_b32 s9, s5
    s_mov_b32 s10, 2359296
    s_mov_b32 s11, 0x00020000
    s_mov_b32 s12, s6
    s_mov_b32 s13, s7
    s_mov_b32 s14, 663552
    s_mov_b32 s15, 0x00020000
    s_add_u32 s16, s28, 8388608
    s_addc_u32 s17, s29, 0
    s_mov_b32 s18, 2359296
    s_mov_b32 s19, 0x00020000
    s_add_u32 s20, s28, 11010048
    s_addc_u32 s21, s29, 0
    s_mov_b32 s22, 2359296
    s_mov_b32 s23, 0x00020000
    s_add_u32 s44, s28, 16252928
    s_addc_u32 s45, s29, 0
    s_mov_b32 s46, 98304
    s_mov_b32 s47, 0x00020000
    s_cmp_ge_u32 s26, 4
    s_cbranch_scc0 oproj_kernel_cons
    s_sub_u32 s26, s26, 4
    s_lshl_b32 s30, s26, 2
    v_add_u32 v10, s30, v2
    v_and_b32 v10, 7, v10
    v_and_b32 v11, 7, v1
    v_xor_b32 v10, v10, v11
    v_lshrrev_b32 v11, 3, v1
    s_lshl_b32 s30, s25, 6
    s_lshl_b32 s31, s26, 3
    s_add_u32 s30, s30, s31
    v_add_u32 v11, s30, v11
    v_mul_u32_u24 v11, 1152, v11
    v_lshl_add_u32 v5, v10, 4, v11
    s_mul_i32 s30, s26, 192
    s_mul_i32 s31, s24, 192
    v_add_u32 v20, s30, v1
    v_mul_u32_u24 v21, 43691, v20
    v_lshrrev_b32 v21, 19, v21
    v_mul_u32_u24 v22, 12, v21
    v_sub_u32 v22, v20, v22
    v_lshrrev_b32 v23, 2, v21
    v_and_b32 v23, 2, v23
    v_xor_b32 v22, v22, v23
    v_mul_u32_u24 v21, 1152, v21
    v_lshl_add_u32 v21, v22, 4, v21
    v_add_u32 v6, s31, v21
    v_add_u32 v20, s30, v1
    v_add_u32 v20, 64, v20
    v_mul_u32_u24 v21, 43691, v20
    v_lshrrev_b32 v21, 19, v21
    v_mul_u32_u24 v22, 12, v21
    v_sub_u32 v22, v20, v22
    v_lshrrev_b32 v23, 2, v21
    v_and_b32 v23, 2, v23
    v_xor_b32 v22, v22, v23
    v_mul_u32_u24 v21, 1152, v21
    v_lshl_add_u32 v21, v22, 4, v21
    v_add_u32 v7, s31, v21
    v_add_u32 v20, s30, v1
    v_add_u32 v20, 128, v20
    v_mul_u32_u24 v21, 43691, v20
    v_lshrrev_b32 v21, 19, v21
    v_mul_u32_u24 v22, 12, v21
    v_sub_u32 v22, v20, v22
    v_lshrrev_b32 v23, 2, v21
    v_and_b32 v23, 2, v23
    v_xor_b32 v22, v22, v23
    v_mul_u32_u24 v21, 1152, v21
    v_lshl_add_u32 v21, v22, 4, v21
    v_add_u32 v8, s31, v21
    s_lshl_b32 s46, s26, 10
    s_mul_i32 s45, s26, 3072
    s_add_u32 s45, s45, 8192
    s_mov_b32 s35, 0
    s_mov_b32 s36, 0
    s_mov_b32 s34, 0
    s_add_u32 s37, s34, s46
    s_add_u32 m0, s37, 0
    s_add_u32 s38, s35, 0
    buffer_load_dwordx4 v5, s[16:19], s38 offen lds
    s_add_u32 m0, s37, 4096
    s_add_u32 s38, s35, 36864
    buffer_load_dwordx4 v5, s[16:19], s38 offen lds
    s_add_u32 s37, s34, s45
    s_add_u32 m0, s37, 0
    s_nop 0
    buffer_load_dwordx4 v6, s[12:15], s36 offen lds
    s_add_u32 m0, s37, 1024
    s_nop 0
    buffer_load_dwordx4 v7, s[12:15], s36 offen lds
    s_add_u32 m0, s37, 2048
    s_nop 0
    buffer_load_dwordx4 v8, s[12:15], s36 offen lds
    s_add_u32 s35, s35, 128
    s_add_u32 s36, s36, 73728
    s_add_u32 s34, s34, 20480
    s_cmp_eq_u32 s34, 122880
    s_cselect_b32 s34, 0, s34
    s_add_u32 s37, s34, s46
    s_add_u32 m0, s37, 0
    s_add_u32 s38, s35, 0
    buffer_load_dwordx4 v5, s[16:19], s38 offen lds
    s_add_u32 m0, s37, 4096
    s_add_u32 s38, s35, 36864
    buffer_load_dwordx4 v5, s[16:19], s38 offen lds
    s_add_u32 s37, s34, s45
    s_add_u32 m0, s37, 0
    s_nop 0
    buffer_load_dwordx4 v6, s[12:15], s36 offen lds
    s_add_u32 m0, s37, 1024
    s_nop 0
    buffer_load_dwordx4 v7, s[12:15], s36 offen lds
    s_add_u32 m0, s37, 2048
    s_nop 0
    buffer_load_dwordx4 v8, s[12:15], s36 offen lds
    s_add_u32 s35, s35, 128
    s_add_u32 s36, s36, 73728
    s_add_u32 s34, s34, 20480
    s_cmp_eq_u32 s34, 122880
    s_cselect_b32 s34, 0, s34
    s_add_u32 s37, s34, s46
    s_add_u32 m0, s37, 0
    s_add_u32 s38, s35, 0
    buffer_load_dwordx4 v5, s[16:19], s38 offen lds
    s_add_u32 m0, s37, 4096
    s_add_u32 s38, s35, 36864
    buffer_load_dwordx4 v5, s[16:19], s38 offen lds
    s_add_u32 s37, s34, s45
    s_add_u32 m0, s37, 0
    s_nop 0
    buffer_load_dwordx4 v6, s[12:15], s36 offen lds
    s_add_u32 m0, s37, 1024
    s_nop 0
    buffer_load_dwordx4 v7, s[12:15], s36 offen lds
    s_add_u32 m0, s37, 2048
    s_nop 0
    buffer_load_dwordx4 v8, s[12:15], s36 offen lds
    s_add_u32 s35, s35, 128
    s_add_u32 s36, s36, 73728
    s_add_u32 s34, s34, 20480
    s_cmp_eq_u32 s34, 122880
    s_cselect_b32 s34, 0, s34
    s_add_u32 s37, s34, s46
    s_add_u32 m0, s37, 0
    s_add_u32 s38, s35, 0
    buffer_load_dwordx4 v5, s[16:19], s38 offen lds
    s_add_u32 m0, s37, 4096
    s_add_u32 s38, s35, 36864
    buffer_load_dwordx4 v5, s[16:19], s38 offen lds
    s_add_u32 s37, s34, s45
    s_add_u32 m0, s37, 0
    s_nop 0
    buffer_load_dwordx4 v6, s[12:15], s36 offen lds
    s_add_u32 m0, s37, 1024
    s_nop 0
    buffer_load_dwordx4 v7, s[12:15], s36 offen lds
    s_add_u32 m0, s37, 2048
    s_nop 0
    buffer_load_dwordx4 v8, s[12:15], s36 offen lds
    s_add_u32 s35, s35, 128
    s_add_u32 s36, s36, 73728
    s_add_u32 s34, s34, 20480
    s_cmp_eq_u32 s34, 122880
    s_cselect_b32 s34, 0, s34
    s_add_u32 s37, s34, s46
    s_add_u32 m0, s37, 0
    s_add_u32 s38, s35, 0
    buffer_load_dwordx4 v5, s[16:19], s38 offen lds
    s_add_u32 m0, s37, 4096
    s_add_u32 s38, s35, 36864
    buffer_load_dwordx4 v5, s[16:19], s38 offen lds
    s_add_u32 s37, s34, s45
    s_add_u32 m0, s37, 0
    s_nop 0
    buffer_load_dwordx4 v6, s[12:15], s36 offen lds
    s_add_u32 m0, s37, 1024
    s_nop 0
    buffer_load_dwordx4 v7, s[12:15], s36 offen lds
    s_add_u32 m0, s37, 2048
    s_nop 0
    buffer_load_dwordx4 v8, s[12:15], s36 offen lds
    s_add_u32 s35, s35, 128
    s_add_u32 s36, s36, 73728
    s_add_u32 s34, s34, 20480
    s_cmp_eq_u32 s34, 122880
    s_cselect_b32 s34, 0, s34
    s_waitcnt vmcnt(20)
    s_barrier
    s_mov_b32 s40, 0
oproj_kernel_lloop:
    s_waitcnt vmcnt(15)
    s_barrier
    s_add_u32 s37, s34, s46
    s_add_u32 m0, s37, 0
    s_add_u32 s38, s35, 0
    buffer_load_dwordx4 v5, s[16:19], s38 offen lds
    s_add_u32 m0, s37, 4096
    s_add_u32 s38, s35, 36864
    buffer_load_dwordx4 v5, s[16:19], s38 offen lds
    s_add_u32 s37, s34, s45
    s_add_u32 m0, s37, 0
    s_nop 0
    buffer_load_dwordx4 v6, s[12:15], s36 offen lds
    s_add_u32 m0, s37, 1024
    s_nop 0
    buffer_load_dwordx4 v7, s[12:15], s36 offen lds
    s_add_u32 m0, s37, 2048
    s_nop 0
    buffer_load_dwordx4 v8, s[12:15], s36 offen lds
    s_add_u32 s35, s35, 128
    s_add_u32 s36, s36, 73728
    s_add_u32 s34, s34, 20480
    s_cmp_eq_u32 s34, 122880
    s_cselect_b32 s34, 0, s34
    s_add_u32 s40, s40, 1
    s_cmp_lt_u32 s40, 4
    s_cbranch_scc1 oproj_kernel_lloop
    s_waitcnt vmcnt(15)
    s_barrier
    s_waitcnt vmcnt(10)
    s_barrier
    s_waitcnt vmcnt(5)
    s_barrier
    s_waitcnt vmcnt(0)
    s_barrier
    s_waitcnt vmcnt(0)
    s_barrier
    s_endpgm
oproj_kernel_cons:
    s_lshr_b32 s41, s26, 1
    s_and_b32 s42, s26, 1
    v_lshrrev_b32 v110, 1, v3
    v_xor_b32 v111, v2, v110
    s_lshl_b32 s30, s41, 5
    v_add_u32 v112, s30, v3
    v_lshlrev_b32 v112, 7, v112
    v_lshl_add_u32 v6, v111, 4, v112
    v_xor_b32 v111, 4, v111
    v_lshl_add_u32 v7, v111, 4, v112
    v_lshrrev_b32 v110, 2, v3
    v_and_b32 v111, 3, v3
    v_lshl_add_u32 v112, v2, 3, v110
    v_mul_u32_u24 v112, 192, v112
    v_and_b32 v113, 1, v111
    v_lshl_add_u32 v112, v113, 3, v112
    v_add_u32 v112, 8192, v112
    v_lshrrev_b32 v113, 1, v111
    s_mul_i32 s30, s42, 6
    v_add_u32 v113, s30, v113
    v_and_b32 v114, 1, v2
    v_lshlrev_b32 v114, 1, v114
    v_add_u32 v115, 0, v113
    v_xor_b32 v115, v115, v114
    v_lshl_add_u32 v8, v115, 4, v112
    v_add_u32 v115, 2, v113
    v_xor_b32 v115, v115, v114
    v_lshl_add_u32 v9, v115, 4, v112
    v_add_u32 v115, 4, v113
    v_xor_b32 v115, v115, v114
    v_lshl_add_u32 v10, v115, 4, v112
    v_mov_b32 v72, 0
    v_mov_b32 v73, 0
    v_mov_b32 v74, 0
    v_mov_b32 v75, 0
    v_mov_b32 v76, 0
    v_mov_b32 v77, 0
    v_mov_b32 v78, 0
    v_mov_b32 v79, 0
    v_mov_b32 v80, 0
    v_mov_b32 v81, 0
    v_mov_b32 v82, 0
    v_mov_b32 v83, 0
    v_mov_b32 v84, 0
    v_mov_b32 v85, 0
    v_mov_b32 v86, 0
    v_mov_b32 v87, 0
    v_mov_b32 v88, 0
    v_mov_b32 v89, 0
    v_mov_b32 v90, 0
    v_mov_b32 v91, 0
    v_mov_b32 v92, 0
    v_mov_b32 v93, 0
    v_mov_b32 v94, 0
    v_mov_b32 v95, 0
    s_lshl_b32 s27, s25, 6
    s_lshl_b32 s30, s41, 5
    s_add_u32 s27, s27, s30
    v_add_u32 v110, s27, v3
    v_mul_u32_u24 v111, 1152, v110
    v_lshl_add_u32 v111, v2, 3, v111
    s_mul_i32 s30, s24, 192
    s_mul_i32 s31, s42, 96
    s_add_u32 s30, s30, s31
    v_add_u32 v111, s30, v111
    s_mov_b32 s43, 18432
    buffer_load_dwordx2 v[96:97], v111, s[8:11], 0 offen offset:0
    buffer_load_dwordx2 v[98:99], v111, s[8:11], 0 offen offset:32
    buffer_load_dwordx2 v[100:101], v111, s[8:11], 0 offen offset:64
    buffer_load_dwordx2 v[102:103], v111, s[8:11], s43 offen offset:0
    buffer_load_dwordx2 v[104:105], v111, s[8:11], s43 offen offset:32
    buffer_load_dwordx2 v[106:107], v111, s[8:11], s43 offen offset:64
    v_mul_u32_u24 v110, 192, v110
    v_lshl_add_u32 v110, v2, 3, v110
    s_mul_i32 s30, s24, 393216
    s_add_u32 s30, s30, s31
    v_add_u32 v108, s30, v110
    v_mov_b32 v11, v6
    v_mov_b32 v16, v6
    v_mov_b32 v12, v7
    v_mov_b32 v17, v7
    v_mov_b32 v13, v8
    v_mov_b32 v18, v8
    v_mov_b32 v14, v9
    v_mov_b32 v19, v9
    v_mov_b32 v15, v10
    v_mov_b32 v20, v10
    s_mov_b32 s39, 0
    s_mov_b32 s40, 0
    s_barrier
    ds_read_b128 v[24:27], v16 offset:0
    ds_read_b128 v[28:31], v16 offset:2048
    ds_read_b64_tr_b16 v[40:41], v18 offset:0
    ds_read_b64_tr_b16 v[42:43], v18 offset:768
    ds_read_b64_tr_b16 v[44:45], v19 offset:0
    ds_read_b64_tr_b16 v[46:47], v19 offset:768
    ds_read_b64_tr_b16 v[48:49], v20 offset:0
    ds_read_b64_tr_b16 v[50:51], v20 offset:768
oproj_kernel_loop0:
    s_add_u32 s39, s39, 20480
    s_cmp_eq_u32 s39, 122880
    s_cselect_b32 s39, 0, s39
    v_mov_b32 v11, v16
    v_add_u32 v16, s39, v6
    v_mov_b32 v12, v17
    v_add_u32 v17, s39, v7
    v_mov_b32 v13, v18
    v_add_u32 v18, s39, v8
    v_mov_b32 v14, v19
    v_add_u32 v19, s39, v9
    v_mov_b32 v15, v20
    v_add_u32 v20, s39, v10
    s_waitcnt lgkmcnt(4)
    v_mfma_f32_16x16x32_bf16 v[72:75], v[40:43], v[24:27], v[72:75]
    ds_read_b128 v[32:35], v12 offset:0
    ds_read_b128 v[36:39], v12 offset:2048
    v_mfma_f32_16x16x32_bf16 v[84:87], v[40:43], v[28:31], v[84:87]
    ds_read_b64_tr_b16 v[52:53], v13 offset:6144
    ds_read_b64_tr_b16 v[54:55], v13 offset:6912
    s_waitcnt lgkmcnt(6)
    v_mfma_f32_16x16x32_bf16 v[76:79], v[44:47], v[24:27], v[76:79]
    ds_read_b64_tr_b16 v[56:57], v14 offset:6144
    v_mfma_f32_16x16x32_bf16 v[88:91], v[44:47], v[28:31], v[88:91]
    ds_read_b64_tr_b16 v[58:59], v14 offset:6912
    s_waitcnt lgkmcnt(6)
    v_mfma_f32_16x16x32_bf16 v[80:83], v[48:51], v[24:27], v[80:83]
    ds_read_b64_tr_b16 v[60:61], v15 offset:6144
    v_mfma_f32_16x16x32_bf16 v[92:95], v[48:51], v[28:31], v[92:95]
    ds_read_b64_tr_b16 v[62:63], v15 offset:6912
    s_barrier
    s_waitcnt lgkmcnt(4)
    v_mfma_f32_16x16x32_bf16 v[72:75], v[52:55], v[32:35], v[72:75]
    ds_read_b128 v[24:27], v16 offset:0
    ds_read_b128 v[28:31], v16 offset:2048
    v_mfma_f32_16x16x32_bf16 v[84:87], v[52:55], v[36:39], v[84:87]
    ds_read_b64_tr_b16 v[40:41], v18 offset:0
    ds_read_b64_tr_b16 v[42:43], v18 offset:768
    s_waitcnt lgkmcnt(6)
    v_mfma_f32_16x16x32_bf16 v[76:79], v[56:59], v[32:35], v[76:79]
    ds_read_b64_tr_b16 v[44:45], v19 offset:0
    v_mfma_f32_16x16x32_bf16 v[88:91], v[56:59], v[36:39], v[88:91]
    ds_read_b64_tr_b16 v[46:47], v19 offset:768
    s_waitcnt lgkmcnt(6)
    v_mfma_f32_16x16x32_bf16 v[80:83], v[60:63], v[32:35], v[80:83]
    ds_read_b64_tr_b16 v[48:49], v20 offset:0
    v_mfma_f32_16x16x32_bf16 v[92:95], v[60:63], v[36:39], v[92:95]
    ds_read_b64_tr_b16 v[50:51], v20 offset:768
    s_add_u32 s40, s40, 1
    s_cmp_lt_u32 s40, 9
    s_cbranch_scc1 oproj_kernel_loop0
    s_waitcnt lgkmcnt(0)
    s_waitcnt vmcnt(0)
    s_nop 7
    v_mov_b32 v24, 0
    v_mov_b32 v25, 0
    v_mov_b32 v26, 0
    v_mov_b32 v27, 0
    v_lshlrev_b32 v40, 16, v96
    v_and_b32 v41, 0xffff0000, v96
    v_lshlrev_b32 v42, 16, v97
    v_and_b32 v43, 0xffff0000, v97
    v_add_f32 v40, v40, v72
    v_add_f32 v41, v41, v73
    v_add_f32 v42, v42, v74
    v_add_f32 v43, v43, v75
    v_cvt_pk_bf16_f32 v96, v40, v41
    v_cvt_pk_bf16_f32 v97, v42, v43
    buffer_store_dwordx2 v[96:97], v108, s[20:23], 0 offen offset:0
    v_lshlrev_b32 v40, 16, v96
    v_and_b32 v41, 0xffff0000, v96
    v_lshlrev_b32 v42, 16, v97
    v_and_b32 v43, 0xffff0000, v97
    v_add_f32 v24, v24, v40
    v_fmac_f32 v26, v40, v40
    v_add_f32 v24, v24, v41
    v_fmac_f32 v26, v41, v41
    v_add_f32 v24, v24, v42
    v_fmac_f32 v26, v42, v42
    v_add_f32 v24, v24, v43
    v_fmac_f32 v26, v43, v43
    v_lshlrev_b32 v40, 16, v98
    v_and_b32 v41, 0xffff0000, v98
    v_lshlrev_b32 v42, 16, v99
    v_and_b32 v43, 0xffff0000, v99
    v_add_f32 v40, v40, v76
    v_add_f32 v41, v41, v77
    v_add_f32 v42, v42, v78
    v_add_f32 v43, v43, v79
    v_cvt_pk_bf16_f32 v98, v40, v41
    v_cvt_pk_bf16_f32 v99, v42, v43
    buffer_store_dwordx2 v[98:99], v108, s[20:23], 0 offen offset:32
    v_lshlrev_b32 v40, 16, v98
    v_and_b32 v41, 0xffff0000, v98
    v_lshlrev_b32 v42, 16, v99
    v_and_b32 v43, 0xffff0000, v99
    v_add_f32 v24, v24, v40
    v_fmac_f32 v26, v40, v40
    v_add_f32 v24, v24, v41
    v_fmac_f32 v26, v41, v41
    v_add_f32 v24, v24, v42
    v_fmac_f32 v26, v42, v42
    v_add_f32 v24, v24, v43
    v_fmac_f32 v26, v43, v43
    v_lshlrev_b32 v40, 16, v100
    v_and_b32 v41, 0xffff0000, v100
    v_lshlrev_b32 v42, 16, v101
    v_and_b32 v43, 0xffff0000, v101
    v_add_f32 v40, v40, v80
    v_add_f32 v41, v41, v81
    v_add_f32 v42, v42, v82
    v_add_f32 v43, v43, v83
    v_cvt_pk_bf16_f32 v100, v40, v41
    v_cvt_pk_bf16_f32 v101, v42, v43
    buffer_store_dwordx2 v[100:101], v108, s[20:23], 0 offen offset:64
    v_lshlrev_b32 v40, 16, v100
    v_and_b32 v41, 0xffff0000, v100
    v_lshlrev_b32 v42, 16, v101
    v_and_b32 v43, 0xffff0000, v101
    v_add_f32 v24, v24, v40
    v_fmac_f32 v26, v40, v40
    v_add_f32 v24, v24, v41
    v_fmac_f32 v26, v41, v41
    v_add_f32 v24, v24, v42
    v_fmac_f32 v26, v42, v42
    v_add_f32 v24, v24, v43
    v_fmac_f32 v26, v43, v43
    v_lshlrev_b32 v40, 16, v102
    v_and_b32 v41, 0xffff0000, v102
    v_lshlrev_b32 v42, 16, v103
    v_and_b32 v43, 0xffff0000, v103
    v_add_f32 v40, v40, v84
    v_add_f32 v41, v41, v85
    v_add_f32 v42, v42, v86
    v_add_f32 v43, v43, v87
    v_cvt_pk_bf16_f32 v102, v40, v41
    v_cvt_pk_bf16_f32 v103, v42, v43
    buffer_store_dwordx2 v[102:103], v108, s[20:23], 0 offen offset:3072
    v_lshlrev_b32 v40, 16, v102
    v_and_b32 v41, 0xffff0000, v102
    v_lshlrev_b32 v42, 16, v103
    v_and_b32 v43, 0xffff0000, v103
    v_add_f32 v25, v25, v40
    v_fmac_f32 v27, v40, v40
    v_add_f32 v25, v25, v41
    v_fmac_f32 v27, v41, v41
    v_add_f32 v25, v25, v42
    v_fmac_f32 v27, v42, v42
    v_add_f32 v25, v25, v43
    v_fmac_f32 v27, v43, v43
    v_lshlrev_b32 v40, 16, v104
    v_and_b32 v41, 0xffff0000, v104
    v_lshlrev_b32 v42, 16, v105
    v_and_b32 v43, 0xffff0000, v105
    v_add_f32 v40, v40, v88
    v_add_f32 v41, v41, v89
    v_add_f32 v42, v42, v90
    v_add_f32 v43, v43, v91
    v_cvt_pk_bf16_f32 v104, v40, v41
    v_cvt_pk_bf16_f32 v105, v42, v43
    buffer_store_dwordx2 v[104:105], v108, s[20:23], 0 offen offset:3104
    v_lshlrev_b32 v40, 16, v104
    v_and_b32 v41, 0xffff0000, v104
    v_lshlrev_b32 v42, 16, v105
    v_and_b32 v43, 0xffff0000, v105
    v_add_f32 v25, v25, v40
    v_fmac_f32 v27, v40, v40
    v_add_f32 v25, v25, v41
    v_fmac_f32 v27, v41, v41
    v_add_f32 v25, v25, v42
    v_fmac_f32 v27, v42, v42
    v_add_f32 v25, v25, v43
    v_fmac_f32 v27, v43, v43
    v_lshlrev_b32 v40, 16, v106
    v_and_b32 v41, 0xffff0000, v106
    v_lshlrev_b32 v42, 16, v107
    v_and_b32 v43, 0xffff0000, v107
    v_add_f32 v40, v40, v92
    v_add_f32 v41, v41, v93
    v_add_f32 v42, v42, v94
    v_add_f32 v43, v43, v95
    v_cvt_pk_bf16_f32 v106, v40, v41
    v_cvt_pk_bf16_f32 v107, v42, v43
    buffer_store_dwordx2 v[106:107], v108, s[20:23], 0 offen offset:3136
    v_lshlrev_b32 v40, 16, v106
    v_and_b32 v41, 0xffff0000, v106
    v_lshlrev_b32 v42, 16, v107
    v_and_b32 v43, 0xffff0000, v107
    v_add_f32 v25, v25, v40
    v_fmac_f32 v27, v40, v40
    v_add_f32 v25, v25, v41
    v_fmac_f32 v27, v41, v41
    v_add_f32 v25, v25, v42
    v_fmac_f32 v27, v42, v42
    v_add_f32 v25, v25, v43
    v_fmac_f32 v27, v43, v43
    v_xor_b32 v30, 16, v1
    v_lshlrev_b32 v30, 2, v30
    v_xor_b32 v31, 32, v1
    v_lshlrev_b32 v31, 2, v31
    ds_bpermute_b32 v32, v30, v24
    ds_bpermute_b32 v33, v30, v25
    ds_bpermute_b32 v34, v30, v26
    ds_bpermute_b32 v35, v30, v27
    s_waitcnt lgkmcnt(0)
    v_add_f32 v24, v24, v32
    v_add_f32 v25, v25, v33
    v_add_f32 v26, v26, v34
    v_add_f32 v27, v27, v35
    ds_bpermute_b32 v32, v31, v24
    ds_bpermute_b32 v33, v31, v25
    ds_bpermute_b32 v34, v31, v26
    ds_bpermute_b32 v35, v31, v27
    s_waitcnt lgkmcnt(0)
    v_add_f32 v24, v24, v32
    v_add_f32 v25, v25, v33
    v_add_f32 v26, v26, v34
    v_add_f32 v27, v27, v35
    s_lshl_b32 s30, s26, 8
    s_add_u32 s30, s30, 122880
    v_lshl_add_u32 v36, v3, 3, s30
    v_mov_b32 v40, v24
    v_mov_b32 v41, v26
    ds_write_b64 v36, v[40:41] offset:0
    v_mov_b32 v42, v25
    v_mov_b32 v43, v27
    ds_write_b64 v36, v[42:43] offset:128
    s_waitcnt lgkmcnt(0)
    s_barrier
    s_cmp_eq_u32 s42, 0
    s_cbranch_scc0 oproj_kernel_done
    ds_read_b64 v[44:45], v36 offset:256
    ds_read_b64 v[46:47], v36 offset:384
    s_lshl_b32 s30, s24, 11
    s_add_u32 s30, s30, s27
    v_add_u32 v37, s30, v3
    v_lshlrev_b32 v37, 3, v37
    v_cmp_gt_u32 vcc, 16, v1
    s_waitcnt lgkmcnt(0)
    v_add_f32 v40, v40, v44
    v_add_f32 v41, v41, v45
    v_add_f32 v42, v42, v46
    v_add_f32 v43, v43, v47
    s_and_saveexec_b64 s[52:53], vcc
    buffer_store_dwordx2 v[40:41], v37, s[44:47], 0 offen offset:0
    buffer_store_dwordx2 v[42:43], v37, s[44:47], 0 offen offset:128
    s_mov_b64 exec, s[52:53]
oproj_kernel_done:
oproj_kernel_end:
    s_endpgm

.globl ln_kernel
.p2align 8
.type ln_kernel,@function
ln_kernel:
    s_cmp_ge_u32 s2, 576
    s_cbranch_scc1 ln_kernel_end
    s_load_dwordx2 s[28:29], s[0:1], 80
    s_lshl_b32 s3, s2, 8
    v_add_u32 v1, s3, v0
    v_lshlrev_b32 v2, 4, v1
    s_mul_i32 s4, s2, 683
    s_lshr_b32 s4, s4, 16
    s_mul_i32 s4, s4, 24576
    v_subrev_u32 v3, s4, v1
    v_mul_u32_u24 v3, 43691, v3
    v_lshrrev_b32 v3, 19, v3
    v_lshlrev_b32 v3, 3, v3
    s_waitcnt lgkmcnt(0)
    s_add_u32 s8, s28, 11010048
    s_addc_u32 s9, s29, 0
    s_mov_b32 s10, 2359296
    s_mov_b32 s11, 0x00020000
    s_add_u32 s12, s28, 13631488
    s_addc_u32 s13, s29, 0
    s_mov_b32 s14, 2359296
    s_mov_b32 s15, 0x00020000
    s_add_u32 s16, s28, 16252928
    s_addc_u32 s17, s29, 0
    s_mov_b32 s18, 98304
    s_mov_b32 s19, 0x00020000
    buffer_load_dwordx4 v[4:7], v2, s[8:11], 0 offen
    s_mov_b32 s20, 0
    buffer_load_dwordx2 v[8:9], v3, s[16:19], s20 offen
    s_mov_b32 s20, 16384
    buffer_load_dwordx2 v[10:11], v3, s[16:19], s20 offen
    s_mov_b32 s20, 32768
    buffer_load_dwordx2 v[12:13], v3, s[16:19], s20 offen
    s_mov_b32 s20, 49152
    buffer_load_dwordx2 v[14:15], v3, s[16:19], s20 offen
    s_mov_b32 s20, 65536
    buffer_load_dwordx2 v[16:17], v3, s[16:19], s20 offen
    s_mov_b32 s20, 81920
    buffer_load_dwordx2 v[18:19], v3, s[16:19], s20 offen
    s_mov_b32 s41, 0x3ae38e39
    s_mov_b32 s42, 0x3727c5ac
    s_waitcnt vmcnt(0)
    v_add_f32 v8, v8, v10
    v_add_f32 v12, v12, v14
    v_add_f32 v16, v16, v18
    v_add_f32 v8, v8, v12
    v_add_f32 v8, v8, v16
    v_add_f32 v9, v9, v11
    v_add_f32 v13, v13, v15
    v_add_f32 v17, v17, v19
    v_add_f32 v9, v9, v13
    v_add_f32 v9, v9, v17
    v_mul_f32 v8, s41, v8
    v_mul_f32 v9, s41, v9
    v_fma_f32 v9, -v8, v8, v9
    v_max_f32 v9, 0, v9
    v_add_f32 v10, s42, v9
    v_rcp_f32 v11, v10
    v_rsq_f32 v12, v10
    s_nop 0
    v_mul_f32 v11, v11, v9
    v_add_f32 v11, s42, v11
    v_rsq_f32 v11, v11
    s_nop 0
    v_mul_f32 v14, v11, v12
    v_mul_f32 v15, v14, v8
    v_lshlrev_b32 v20, 16, v4
    v_and_b32 v21, 0xffff0000, v4
    v_fma_f32 v20, v20, v14, -v15
    v_fma_f32 v21, v21, v14, -v15
    v_cvt_pk_bf16_f32 v4, v20, v21
    v_lshlrev_b32 v20, 16, v5
    v_and_b32 v21, 0xffff0000, v5
    v_fma_f32 v20, v20, v14, -v15
    v_fma_f32 v21, v21, v14, -v15
    v_cvt_pk_bf16_f32 v5, v20, v21
    v_lshlrev_b32 v20, 16, v6
    v_and_b32 v21, 0xffff0000, v6
    v_fma_f32 v20, v20, v14, -v15
    v_fma_f32 v21, v21, v14, -v15
    v_cvt_pk_bf16_f32 v6, v20, v21
    v_lshlrev_b32 v20, 16, v7
    v_and_b32 v21, 0xffff0000, v7
    v_fma_f32 v20, v20, v14, -v15
    v_fma_f32 v21, v21, v14, -v15
    v_cvt_pk_bf16_f32 v7, v20, v21
    buffer_store_dwordx4 v[4:7], v2, s[12:15], 0 offen
ln_kernel_end:
    s_endpgm

.globl mlp1_kernel
.p2align 8
.type mlp1_kernel,@function
mlp1_kernel:
    s_cmp_ge_u32 s2, 216
    s_cbranch_scc1 mlp1_kernel_end
    s_load_dwordx2 s[4:5], s[0:1], 32
    s_load_dwordx2 s[6:7], s[0:1], 40
    s_load_dwordx2 s[28:29], s[0:1], 80
    s_load_dwordx2 s[64:65], s[0:1], 48
    v_and_b32 v1, 63, v0
    v_lshrrev_b32 v2, 4, v1
    v_and_b32 v3, 15, v1
    v_lshrrev_b32 v4, 6, v0
    s_nop 1
    v_readfirstlane_b32 s26, v4
    s_and_b32 s24, s2, 7
    s_mul_i32 s24, s24, 27
    s_lshr_b32 s25, s2, 3
    s_add_u32 s24, s24, s25
    s_mul_i32 s25, s24, 10923
    s_lshr_b32 s25, s25, 16
    s_mul_i32 s30, s25, 6
    s_sub_u32 s24, s24, s30
    s_waitcnt lgkmcnt(0)
    s_mov_b32 s8, s4
    s_mov_b32 s9, s5
    s_mov_b32 s10, 18874368
    s_mov_b32 s11, 0x00020000
    s_mov_b32 s12, s6
    s_mov_b32 s13, s7
    s_mov_b32 s14, 9216
    s_mov_b32 s15, 0x00020000
    s_add_u32 s16, s28, 13631488
    s_addc_u32 s17, s29, 0
    s_mov_b32 s18, 2359296
    s_mov_b32 s19, 0x00020000
    s_add_u32 s20, s28, 16777216
    s_addc_u32 s21, s29, 0
    s_mov_b32 s22, 5308416
    s_mov_b32 s23, 0x00020000
    s_mov_b32 s68, s64
    s_mov_b32 s69, s65
    s_mov_b32 s70, 18874368
    s_mov_b32 s71, 0x00020000
    s_cmp_ge_u32 s2, 216
    s_cbranch_scc0 mlp1_kernel_work
    s_and_b32 s52, s2, 7
    s_lshr_b32 s53, s2, 3
    s_sub_u32 s54, s53, 27
    s_lshl_b32 s54, s54, 3
    s_add_u32 s54, s54, s26
    s_mul_i32 s54, s54, 116
    s_add_u32 s54, s54, 13824
    s_lshr_b32 s56, s52, 1
    s_mul_i32 s56, s56, 4718592
    s_and_b32 s57, s52, 1
    s_lshl_b32 s57, s57, 11
    s_add_u32 s56, s56, s57
    s_mov_b32 exec_hi, 0xffff
    s_endpgm
mlp1_kernel_work:
    s_cmp_ge_u32 s26, 4
    s_cbranch_scc0 mlp1_kernel_cons
    s_sub_u32 s26, s26, 4
    s_lshl_b32 s30, s26, 4
    v_add_u32 v10, s30, v2
    v_mul_u32_u24 v10, 9216, v10
    v_lshlrev_b32 v11, 2, v2
    v_xor_b32 v11, v11, v3
    v_lshl_add_u32 v10, v11, 4, v10
    s_lshl_b32 s30, s25, 8
    v_add_u32 v5, s30, v10
    s_mul_i32 s30, s26, 3072
    s_mul_i32 s31, s24, 393216
    s_add_u32 s30, s30, s31
    v_lshl_add_u32 v6, v1, 4, s30
    s_lshl_b32 s32, s26, 12
    s_mul_i32 s33, s26, 3072
    s_add_u32 s33, s33, 16384
    s_mov_b32 s35, 0
    s_mov_b32 s36, 0
    s_mov_b32 s34, 0
    s_add_u32 s37, s34, s32
    s_add_u32 m0, s37, 0
    s_add_u32 s38, s35, 0
    buffer_load_dwordx4 v5, s[8:11], s38 offen lds
    s_add_u32 m0, s37, 1024
    s_add_u32 s38, s35, 36864
    buffer_load_dwordx4 v5, s[8:11], s38 offen lds
    s_add_u32 m0, s37, 2048
    s_add_u32 s38, s35, 73728
    buffer_load_dwordx4 v5, s[8:11], s38 offen lds
    s_add_u32 m0, s37, 3072
    s_add_u32 s38, s35, 110592
    buffer_load_dwordx4 v5, s[8:11], s38 offen lds
    s_add_u32 m0, s34, s33
    s_nop 0
    buffer_load_dwordx4 v6, s[16:19], s36 offen offset:0 lds
    buffer_load_dwordx4 v6, s[16:19], s36 offen offset:1024 lds
    buffer_load_dwordx4 v6, s[16:19], s36 offen offset:2048 lds
    s_add_u32 s35, s35, 589824
    s_add_u32 s36, s36, 12288
    s_add_u32 s34, s34, 28672
    s_cmp_eq_u32 s34, 143360
    s_cselect_b32 s34, 0, s34
    s_add_u32 s37, s34, s32
    s_add_u32 m0, s37, 0
    s_add_u32 s38, s35, 0
    buffer_load_dwordx4 v5, s[8:11], s38 offen lds
    s_add_u32 m0, s37, 1024
    s_add_u32 s38, s35, 36864
    buffer_load_dwordx4 v5, s[8:11], s38 offen lds
    s_add_u32 m0, s37, 2048
    s_add_u32 s38, s35, 73728
    buffer_load_dwordx4 v5, s[8:11], s38 offen lds
    s_add_u32 m0, s37, 3072
    s_add_u32 s38, s35, 110592
    buffer_load_dwordx4 v5, s[8:11], s38 offen lds
    s_add_u32 m0, s34, s33
    s_nop 0
    buffer_load_dwordx4 v6, s[16:19], s36 offen offset:0 lds
    buffer_load_dwordx4 v6, s[16:19], s36 offen offset:1024 lds
    buffer_load_dwordx4 v6, s[16:19], s36 offen offset:2048 lds
    s_add_u32 s35, s35, 589824
    s_add_u32 s36, s36, 12288
    s_add_u32 s34, s34, 28672
    s_cmp_eq_u32 s34, 143360
    s_cselect_b32 s34, 0, s34
    s_add_u32 s37, s34, s32
    s_add_u32 m0, s37, 0
    s_add_u32 s38, s35, 0
    buffer_load_dwordx4 v5, s[8:11], s38 offen lds
    s_add_u32 m0, s37, 1024
    s_add_u32 s38, s35, 36864
    buffer_load_dwordx4 v5, s[8:11], s38 offen lds
    s_add_u32 m0, s37, 2048
    s_add_u32 s38, s35, 73728
    buffer_load_dwordx4 v5, s[8:11], s38 offen lds
    s_add_u32 m0, s37, 3072
    s_add_u32 s38, s35, 110592
    buffer_load_dwordx4 v5, s[8:11], s38 offen lds
    s_add_u32 m0, s34, s33
    s_nop 0
    buffer_load_dwordx4 v6, s[16:19], s36 offen offset:0 lds
    buffer_load_dwordx4 v6, s[16:19], s36 offen offset:1024 lds
    buffer_load_dwordx4 v6, s[16:19], s36 offen offset:2048 lds
    s_add_u32 s35, s35, 589824
    s_add_u32 s36, s36, 12288
    s_add_u32 s34, s34, 28672
    s_cmp_eq_u32 s34, 143360
    s_cselect_b32 s34, 0, s34
    s_add_u32 s37, s34, s32
    s_add_u32 m0, s37, 0
    s_add_u32 s38, s35, 0
    buffer_load_dwordx4 v5, s[8:11], s38 offen lds
    s_add_u32 m0, s37, 1024
    s_add_u32 s38, s35, 36864
    buffer_load_dwordx4 v5, s[8:11], s38 offen lds
    s_add_u32 m0, s37, 2048
    s_add_u32 s38, s35, 73728
    buffer_load_dwordx4 v5, s[8:11], s38 offen lds
    s_add_u32 m0, s37, 3072
    s_add_u32 s38, s35, 110592
    buffer_load_dwordx4 v5, s[8:11], s38 offen lds
    s_add_u32 m0, s34, s33
    s_nop 0
    buffer_load_dwordx4 v6, s[16:19], s36 offen offset:0 lds
    buffer_load_dwordx4 v6, s[16:19], s36 offen offset:1024 lds
    buffer_load_dwordx4 v6, s[16:19], s36 offen offset:2048 lds
    s_add_u32 s35, s35, 589824
    s_add_u32 s36, s36, 12288
    s_add_u32 s34, s34, 28672
    s_cmp_eq_u32 s34, 143360
    s_cselect_b32 s34, 0, s34
    s_waitcnt vmcnt(21)
    s_barrier
    s_mov_b32 s40, 0
mlp1_kernel_lloop:
    s_waitcnt vmcnt(14)
    s_barrier
    s_add_u32 s37, s34, s32
    s_add_u32 m0, s37, 0
    s_add_u32 s38, s35, 0
    buffer_load_dwordx4 v5, s[8:11], s38 offen lds
    s_add_u32 m0, s37, 1024
    s_add_u32 s38, s35, 36864
    buffer_load_dwordx4 v5, s[8:11], s38 offen lds
    s_add_u32 m0, s37, 2048
    s_add_u32 s38, s35, 73728
    buffer_load_dwordx4 v5, s[8:11], s38 offen lds
    s_add_u32 m0, s37, 3072
    s_add_u32 s38, s35, 110592
    buffer_load_dwordx4 v5, s[8:11], s38 offen lds
    s_add_u32 m0, s34, s33
    s_nop 0
    buffer_load_dwordx4 v6, s[16:19], s36 offen offset:0 lds
    buffer_load_dwordx4 v6, s[16:19], s36 offen offset:1024 lds
    buffer_load_dwordx4 v6, s[16:19], s36 offen offset:2048 lds
    s_add_u32 s35, s35, 589824
    s_add_u32 s36, s36, 12288
    s_add_u32 s34, s34, 28672
    s_cmp_eq_u32 s34, 143360
    s_cselect_b32 s34, 0, s34
    s_add_u32 s40, s40, 1
    s_cmp_lt_u32 s40, 28
    s_cbranch_scc1 mlp1_kernel_lloop
    s_waitcnt vmcnt(14)
    s_barrier
    s_waitcnt vmcnt(7)
    s_barrier
    s_waitcnt vmcnt(0)
    s_barrier
    s_waitcnt vmcnt(0)
    s_barrier
    s_endpgm
mlp1_kernel_cons:
    v_lshrrev_b32 v150, 2, v3
    v_and_b32 v151, 3, v3
    v_lshrrev_b32 v152, 1, v2
    v_and_b32 v153, 1, v2
    v_lshl_add_u32 v154, v152, 3, v150
    v_lshrrev_b32 v155, 1, v151
    v_lshl_add_u32 v155, v153, 1, v155
    s_lshl_b32 s30, s26, 2
    v_add_u32 v155, s30, v155
    v_lshlrev_b32 v156, 2, v150
    v_xor_b32 v155, v155, v156
    v_lshlrev_b32 v155, 4, v155
    v_lshl_add_u32 v155, v154, 8, v155
    v_and_b32 v156, 1, v151
    v_lshl_add_u32 v10, v156, 3, v155
    v_mul_u32_u24 v155, 192, v154
    v_lshl_add_u32 v155, v153, 5, v155
    v_lshl_add_u32 v155, v151, 3, v155
    v_add_u32 v11, 16384, v155
    v_lshrrev_b32 v4, 5, v1
    s_lshl_b32 s30, s25, 8
    s_lshl_b32 s31, s26, 6
    s_add_u32 s30, s30, s31
    v_lshl_add_u32 v150, v4, 3, s30
    buffer_load_dwordx2 v[160:161], v150, s[12:15], 0 offen offset:0
    buffer_load_dwordx2 v[162:163], v150, s[12:15], 0 offen offset:16
    buffer_load_dwordx2 v[164:165], v150, s[12:15], 0 offen offset:32
    buffer_load_dwordx2 v[166:167], v150, s[12:15], 0 offen offset:48
    v_mov_b32 v96, 0
    v_mov_b32 v97, 0
    v_mov_b32 v98, 0
    v_mov_b32 v99, 0
    v_mov_b32 v100, 0
    v_mov_b32 v101, 0
    v_mov_b32 v102, 0
    v_mov_b32 v103, 0
    v_mov_b32 v104, 0
    v_mov_b32 v105, 0
    v_mov_b32 v106, 0
    v_mov_b32 v107, 0
    v_mov_b32 v108, 0
    v_mov_b32 v109, 0
    v_mov_b32 v110, 0
    v_mov_b32 v111, 0
    v_mov_b32 v112, 0
    v_mov_b32 v113, 0
    v_mov_b32 v114, 0
    v_mov_b32 v115, 0
    v_mov_b32 v116, 0
    v_mov_b32 v117, 0
    v_mov_b32 v118, 0
    v_mov_b32 v119, 0
    v_mov_b32 v120, 0
    v_mov_b32 v121, 0
    v_mov_b32 v122, 0
    v_mov_b32 v123, 0
    v_mov_b32 v124, 0
    v_mov_b32 v125, 0
    v_mov_b32 v126, 0
    v_mov_b32 v127, 0
    v_mov_b32 v128, 0
    v_mov_b32 v129, 0
    v_mov_b32 v130, 0
    v_mov_b32 v131, 0
    v_mov_b32 v132, 0
    v_mov_b32 v133, 0
    v_mov_b32 v134, 0
    v_mov_b32 v135, 0
    v_mov_b32 v136, 0
    v_mov_b32 v137, 0
    v_mov_b32 v138, 0
    v_mov_b32 v139, 0
    v_mov_b32 v140, 0
    v_mov_b32 v141, 0
    v_mov_b32 v142, 0
    v_mov_b32 v143, 0
    v_mov_b32 v12, v10
    v_mov_b32 v14, v10
    v_mov_b32 v13, v11
    v_mov_b32 v15, v11
    s_mov_b32 s39, 0
    s_mov_b32 s40, 0
    s_barrier
    ds_read_b64_tr_b16 v[24:25], v14 offset:0
    ds_read_b64_tr_b16 v[26:27], v14 offset:1024
    ds_read_b64_tr_b16 v[40:41], v15 offset:0
    ds_read_b64_tr_b16 v[42:43], v15 offset:768
    ds_read_b64_tr_b16 v[44:45], v15 offset:64
    ds_read_b64_tr_b16 v[46:47], v15 offset:832
    ds_read_b64_tr_b16 v[48:49], v15 offset:128
    ds_read_b64_tr_b16 v[50:51], v15 offset:896
    ds_read_b64_tr_b16 v[28:29], v14 offset:4096
    ds_read_b64_tr_b16 v[30:31], v14 offset:5120
    ds_read_b64_tr_b16 v[52:53], v15 offset:3072
    ds_read_b64_tr_b16 v[54:55], v15 offset:3840
    ds_read_b64_tr_b16 v[56:57], v15 offset:3136
    ds_read_b64_tr_b16 v[58:59], v15 offset:3904
    ds_read_b64_tr_b16 v[60:61], v15 offset:3200
    ds_read_b64_tr_b16 v[62:63], v15 offset:3968
mlp1_kernel_loop0:
    s_add_u32 s39, s39, 28672
    s_cmp_eq_u32 s39, 143360
    s_cselect_b32 s39, 0, s39
    v_mov_b32 v12, v14
    v_add_u32 v14, s39, v10
    v_mov_b32 v13, v15
    v_add_u32 v15, s39, v11
    s_waitcnt lgkmcnt(12)
    v_mfma_f32_32x32x16_bf16 v[96:111], v[24:27], v[40:43], v[96:111]
    ds_read_b64_tr_b16 v[32:33], v12 offset:8192
    ds_read_b64_tr_b16 v[34:35], v12 offset:9216
    ds_read_b64_tr_b16 v[64:65], v13 offset:6144
    s_waitcnt lgkmcnt(13)
    v_mfma_f32_32x32x16_bf16 v[112:127], v[24:27], v[44:47], v[112:127]
    ds_read_b64_tr_b16 v[66:67], v13 offset:6912
    ds_read_b64_tr_b16 v[68:69], v13 offset:6208
    ds_read_b64_tr_b16 v[70:71], v13 offset:6976
    s_waitcnt lgkmcnt(14)
    v_mfma_f32_32x32x16_bf16 v[128:143], v[24:27], v[48:51], v[128:143]
    ds_read_b64_tr_b16 v[72:73], v13 offset:6272
    ds_read_b64_tr_b16 v[74:75], v13 offset:7040
    s_waitcnt lgkmcnt(12)
    v_mfma_f32_32x32x16_bf16 v[96:111], v[28:31], v[52:55], v[96:111]
    ds_read_b64_tr_b16 v[36:37], v12 offset:12288
    ds_read_b64_tr_b16 v[38:39], v12 offset:13312
    ds_read_b64_tr_b16 v[76:77], v13 offset:9216
    s_waitcnt lgkmcnt(13)
    v_mfma_f32_32x32x16_bf16 v[112:127], v[28:31], v[56:59], v[112:127]
    ds_read_b64_tr_b16 v[78:79], v13 offset:9984
    ds_read_b64_tr_b16 v[80:81], v13 offset:9280
    ds_read_b64_tr_b16 v[82:83], v13 offset:10048
    s_waitcnt lgkmcnt(14)
    v_mfma_f32_32x32x16_bf16 v[128:143], v[28:31], v[60:63], v[128:143]
    ds_read_b64_tr_b16 v[84:85], v13 offset:9344
    ds_read_b64_tr_b16 v[86:87], v13 offset:10112
    s_barrier
    s_waitcnt lgkmcnt(12)
    v_mfma_f32_32x32x16_bf16 v[96:111], v[32:35], v[64:67], v[96:111]
    ds_read_b64_tr_b16 v[24:25], v14 offset:0
    ds_read_b64_tr_b16 v[26:27], v14 offset:1024
    ds_read_b64_tr_b16 v[40:41], v15 offset:0
    s_waitcnt lgkmcnt(13)
    v_mfma_f32_32x32x16_bf16 v[112:127], v[32:35], v[68:71], v[112:127]
    ds_read_b64_tr_b16 v[42:43], v15 offset:768
    ds_read_b64_tr_b16 v[44:45], v15 offset:64
    ds_read_b64_tr_b16 v[46:47], v15 offset:832
    s_waitcnt lgkmcnt(14)
    v_mfma_f32_32x32x16_bf16 v[128:143], v[32:35], v[72:75], v[128:143]
    ds_read_b64_tr_b16 v[48:49], v15 offset:128
    ds_read_b64_tr_b16 v[50:51], v15 offset:896
    s_waitcnt lgkmcnt(12)
    v_mfma_f32_32x32x16_bf16 v[96:111], v[36:39], v[76:79], v[96:111]
    ds_read_b64_tr_b16 v[28:29], v14 offset:4096
    ds_read_b64_tr_b16 v[30:31], v14 offset:5120
    ds_read_b64_tr_b16 v[52:53], v15 offset:3072
    s_waitcnt lgkmcnt(13)
    v_mfma_f32_32x32x16_bf16 v[112:127], v[36:39], v[80:83], v[112:127]
    ds_read_b64_tr_b16 v[54:55], v15 offset:3840
    ds_read_b64_tr_b16 v[56:57], v15 offset:3136
    ds_read_b64_tr_b16 v[58:59], v15 offset:3904
    s_waitcnt lgkmcnt(14)
    v_mfma_f32_32x32x16_bf16 v[128:143], v[36:39], v[84:87], v[128:143]
    ds_read_b64_tr_b16 v[60:61], v15 offset:3200
    ds_read_b64_tr_b16 v[62:63], v15 offset:3968
    s_add_u32 s40, s40, 1
    s_cmp_lt_u32 s40, 32
    s_cbranch_scc1 mlp1_kernel_loop0
    s_waitcnt lgkmcnt(0)
    s_barrier
    s_mul_i32 s47, s26, 7680
    v_and_b32 v151, 31, v1
    v_mul_u32_u24 v151, 80, v151
    v_lshl_add_u32 v151, v4, 3, v151
    v_add_u32 v16, s47, v151
    v_lshrrev_b32 v151, 2, v1
    v_and_b32 v152, 3, v1
    v_mul_u32_u24 v153, 80, v151
    v_lshl_add_u32 v153, v152, 4, v153
    v_add_u32 v18, s47, v153
    v_lshlrev_b32 v153, 7, v151
    v_lshl_add_u32 v19, v152, 4, v153
    s_lshr_b32 s31, s26, 1
    s_lshl_b32 s30, s25, 1
    s_add_u32 s31, s31, s30
    s_mul_i32 s31, s31, 73728
    s_and_b32 s30, s26, 1
    s_lshl_b32 s30, s30, 6
    s_add_u32 s31, s31, s30
    s_mul_i32 s30, s24, 12288
    s_add_u32 s42, s31, s30
    s_add_u32 s43, s42, 4096
    s_add_u32 s44, s42, 8192
    s_waitcnt vmcnt(0)
    v_lshlrev_b32 v32, 16, v160
    v_and_b32 v33, 0xffff0000, v160
    v_lshlrev_b32 v34, 16, v161
    v_and_b32 v35, 0xffff0000, v161
    v_lshlrev_b32 v36, 16, v162
    v_and_b32 v37, 0xffff0000, v162
    v_lshlrev_b32 v38, 16, v163
    v_and_b32 v39, 0xffff0000, v163
    v_lshlrev_b32 v40, 16, v164
    v_and_b32 v41, 0xffff0000, v164
    v_lshlrev_b32 v42, 16, v165
    v_and_b32 v43, 0xffff0000, v165
    v_lshlrev_b32 v44, 16, v166
    v_and_b32 v45, 0xffff0000, v166
    v_lshlrev_b32 v46, 16, v167
    v_and_b32 v47, 0xffff0000, v167
    s_mov_b32 s41, 0xbdd2d3e8
    v_mov_b32 v17, 0xc0135761
    v_add_f32 v96, v96, v32
    v_add_f32 v97, v97, v33
    v_add_f32 v98, v98, v34
    v_add_f32 v99, v99, v35
    v_add_f32 v100, v100, v36
    v_add_f32 v101, v101, v37
    v_add_f32 v102, v102, v38
    v_add_f32 v103, v103, v39
    v_mul_f32 v150, v96, v96
    v_mul_f32 v151, v97, v97
    v_mul_f32 v152, v98, v98
    v_mul_f32 v153, v99, v99
    v_mul_f32 v154, v100, v100
    v_mul_f32 v155, v101, v101
    v_mul_f32 v156, v102, v102
    v_mul_f32 v157, v103, v103
    v_fma_f32 v150, v150, s41, v17
    v_fma_f32 v151, v151, s41, v17
    v_fma_f32 v152, v152, s41, v17
    v_fma_f32 v153, v153, s41, v17
    v_fma_f32 v154, v154, s41, v17
    v_fma_f32 v155, v155, s41, v17
    v_fma_f32 v156, v156, s41, v17
    v_fma_f32 v157, v157, s41, v17
    v_mul_f32 v150, v150, v96
    v_mul_f32 v151, v151, v97
    v_mul_f32 v152, v152, v98
    v_mul_f32 v153, v153, v99
    v_mul_f32 v154, v154, v100
    v_mul_f32 v155, v155, v101
    v_mul_f32 v156, v156, v102
    v_mul_f32 v157, v157, v103
    v_exp_f32 v150, v150
    v_exp_f32 v151, v151
    v_exp_f32 v152, v152
    v_exp_f32 v153, v153
    v_exp_f32 v154, v154
    v_exp_f32 v155, v155
    v_exp_f32 v156, v156
    v_exp_f32 v157, v157
    v_add_f32 v150, 1.0, v150
    v_add_f32 v151, 1.0, v151
    v_add_f32 v152, 1.0, v152
    v_add_f32 v153, 1.0, v153
    v_add_f32 v154, 1.0, v154
    v_add_f32 v155, 1.0, v155
    v_add_f32 v156, 1.0, v156
    v_add_f32 v157, 1.0, v157
    v_rcp_f32 v150, v150
    v_rcp_f32 v151, v151
    v_rcp_f32 v152, v152
    v_rcp_f32 v153, v153
    v_rcp_f32 v154, v154
    v_rcp_f32 v155, v155
    v_rcp_f32 v156, v156
    v_rcp_f32 v157, v157
    v_mul_f32 v96, v96, v150
    v_mul_f32 v97, v97, v151
    v_mul_f32 v98, v98, v152
    v_mul_f32 v99, v99, v153
    v_mul_f32 v100, v100, v154
    v_mul_f32 v101, v101, v155
    v_mul_f32 v102, v102, v156
    v_mul_f32 v103, v103, v157
    v_cvt_pk_bf16_f32 v96, v96, v97
    v_cvt_pk_bf16_f32 v97, v98, v99
    ds_write_b64 v16, v[96:97] offset:0
    v_cvt_pk_bf16_f32 v100, v100, v101
    v_cvt_pk_bf16_f32 v101, v102, v103
    ds_write_b64 v16, v[100:101] offset:16
    v_add_f32 v104, v104, v40
    v_add_f32 v105, v105, v41
    v_add_f32 v106, v106, v42
    v_add_f32 v107, v107, v43
    v_add_f32 v108, v108, v44
    v_add_f32 v109, v109, v45
    v_add_f32 v110, v110, v46
    v_add_f32 v111, v111, v47
    v_mul_f32 v150, v104, v104
    v_mul_f32 v151, v105, v105
    v_mul_f32 v152, v106, v106
    v_mul_f32 v153, v107, v107
    v_mul_f32 v154, v108, v108
    v_mul_f32 v155, v109, v109
    v_mul_f32 v156, v110, v110
    v_mul_f32 v157, v111, v111
    v_fma_f32 v150, v150, s41, v17
    v_fma_f32 v151, v151, s41, v17
    v_fma_f32 v152, v152, s41, v17
    v_fma_f32 v153, v153, s41, v17
    v_fma_f32 v154, v154, s41, v17
    v_fma_f32 v155, v155, s41, v17
    v_fma_f32 v156, v156, s41, v17
    v_fma_f32 v157, v157, s41, v17
    v_mul_f32 v150, v150, v104
    v_mul_f32 v151, v151, v105
    v_mul_f32 v152, v152, v106
    v_mul_f32 v153, v153, v107
    v_mul_f32 v154, v154, v108
    v_mul_f32 v155, v155, v109
    v_mul_f32 v156, v156, v110
    v_mul_f32 v157, v157, v111
    v_exp_f32 v150, v150
    v_exp_f32 v151, v151
    v_exp_f32 v152, v152
    v_exp_f32 v153, v153
    v_exp_f32 v154, v154
    v_exp_f32 v155, v155
    v_exp_f32 v156, v156
    v_exp_f32 v157, v157
    v_add_f32 v150, 1.0, v150
    v_add_f32 v151, 1.0, v151
    v_add_f32 v152, 1.0, v152
    v_add_f32 v153, 1.0, v153
    v_add_f32 v154, 1.0, v154
    v_add_f32 v155, 1.0, v155
    v_add_f32 v156, 1.0, v156
    v_add_f32 v157, 1.0, v157
    v_rcp_f32 v150, v150
    v_rcp_f32 v151, v151
    v_rcp_f32 v152, v152
    v_rcp_f32 v153, v153
    v_rcp_f32 v154, v154
    v_rcp_f32 v155, v155
    v_rcp_f32 v156, v156
    v_rcp_f32 v157, v157
    v_mul_f32 v104, v104, v150
    v_mul_f32 v105, v105, v151
    v_mul_f32 v106, v106, v152
    v_mul_f32 v107, v107, v153
    v_mul_f32 v108, v108, v154
    v_mul_f32 v109, v109, v155
    v_mul_f32 v110, v110, v156
    v_mul_f32 v111, v111, v157
    v_cvt_pk_bf16_f32 v104, v104, v105
    v_cvt_pk_bf16_f32 v105, v106, v107
    ds_write_b64 v16, v[104:105] offset:32
    v_cvt_pk_bf16_f32 v108, v108, v109
    v_cvt_pk_bf16_f32 v109, v110, v111
    ds_write_b64 v16, v[108:109] offset:48
    v_add_f32 v112, v112, v32
    v_add_f32 v113, v113, v33
    v_add_f32 v114, v114, v34
    v_add_f32 v115, v115, v35
    v_add_f32 v116, v116, v36
    v_add_f32 v117, v117, v37
    v_add_f32 v118, v118, v38
    v_add_f32 v119, v119, v39
    v_mul_f32 v150, v112, v112
    v_mul_f32 v151, v113, v113
    v_mul_f32 v152, v114, v114
    v_mul_f32 v153, v115, v115
    v_mul_f32 v154, v116, v116
    v_mul_f32 v155, v117, v117
    v_mul_f32 v156, v118, v118
    v_mul_f32 v157, v119, v119
    v_fma_f32 v150, v150, s41, v17
    v_fma_f32 v151, v151, s41, v17
    v_fma_f32 v152, v152, s41, v17
    v_fma_f32 v153, v153, s41, v17
    v_fma_f32 v154, v154, s41, v17
    v_fma_f32 v155, v155, s41, v17
    v_fma_f32 v156, v156, s41, v17
    v_fma_f32 v157, v157, s41, v17
    v_mul_f32 v150, v150, v112
    v_mul_f32 v151, v151, v113
    v_mul_f32 v152, v152, v114
    v_mul_f32 v153, v153, v115
    v_mul_f32 v154, v154, v116
    v_mul_f32 v155, v155, v117
    v_mul_f32 v156, v156, v118
    v_mul_f32 v157, v157, v119
    v_exp_f32 v150, v150
    v_exp_f32 v151, v151
    v_exp_f32 v152, v152
    v_exp_f32 v153, v153
    v_exp_f32 v154, v154
    v_exp_f32 v155, v155
    v_exp_f32 v156, v156
    v_exp_f32 v157, v157
    v_add_f32 v150, 1.0, v150
    v_add_f32 v151, 1.0, v151
    v_add_f32 v152, 1.0, v152
    v_add_f32 v153, 1.0, v153
    v_add_f32 v154, 1.0, v154
    v_add_f32 v155, 1.0, v155
    v_add_f32 v156, 1.0, v156
    v_add_f32 v157, 1.0, v157
    v_rcp_f32 v150, v150
    v_rcp_f32 v151, v151
    v_rcp_f32 v152, v152
    v_rcp_f32 v153, v153
    v_rcp_f32 v154, v154
    v_rcp_f32 v155, v155
    v_rcp_f32 v156, v156
    v_rcp_f32 v157, v157
    v_mul_f32 v112, v112, v150
    v_mul_f32 v113, v113, v151
    v_mul_f32 v114, v114, v152
    v_mul_f32 v115, v115, v153
    v_mul_f32 v116, v116, v154
    v_mul_f32 v117, v117, v155
    v_mul_f32 v118, v118, v156
    v_mul_f32 v119, v119, v157
    v_cvt_pk_bf16_f32 v112, v112, v113
    v_cvt_pk_bf16_f32 v113, v114, v115
    ds_write_b64 v16, v[112:113] offset:2560
    v_cvt_pk_bf16_f32 v116, v116, v117
    v_cvt_pk_bf16_f32 v117, v118, v119
    ds_write_b64 v16, v[116:117] offset:2576
    v_add_f32 v120, v120, v40
    v_add_f32 v121, v121, v41
    v_add_f32 v122, v122, v42
    v_add_f32 v123, v123, v43
    v_add_f32 v124, v124, v44
    v_add_f32 v125, v125, v45
    v_add_f32 v126, v126, v46
    v_add_f32 v127, v127, v47
    v_mul_f32 v150, v120, v120
    v_mul_f32 v151, v121, v121
    v_mul_f32 v152, v122, v122
    v_mul_f32 v153, v123, v123
    v_mul_f32 v154, v124, v124
    v_mul_f32 v155, v125, v125
    v_mul_f32 v156, v126, v126
    v_mul_f32 v157, v127, v127
    v_fma_f32 v150, v150, s41, v17
    v_fma_f32 v151, v151, s41, v17
    v_fma_f32 v152, v152, s41, v17
    v_fma_f32 v153, v153, s41, v17
    v_fma_f32 v154, v154, s41, v17
    v_fma_f32 v155, v155, s41, v17
    v_fma_f32 v156, v156, s41, v17
    v_fma_f32 v157, v157, s41, v17
    v_mul_f32 v150, v150, v120
    v_mul_f32 v151, v151, v121
    v_mul_f32 v152, v152, v122
    v_mul_f32 v153, v153, v123
    v_mul_f32 v154, v154, v124
    v_mul_f32 v155, v155, v125
    v_mul_f32 v156, v156, v126
    v_mul_f32 v157, v157, v127
    v_exp_f32 v150, v150
    v_exp_f32 v151, v151
    v_exp_f32 v152, v152
    v_exp_f32 v153, v153
    v_exp_f32 v154, v154
    v_exp_f32 v155, v155
    v_exp_f32 v156, v156
    v_exp_f32 v157, v157
    v_add_f32 v150, 1.0, v150
    v_add_f32 v151, 1.0, v151
    v_add_f32 v152, 1.0, v152
    v_add_f32 v153, 1.0, v153
    v_add_f32 v154, 1.0, v154
    v_add_f32 v155, 1.0, v155
    v_add_f32 v156, 1.0, v156
    v_add_f32 v157, 1.0, v157
    v_rcp_f32 v150, v150
    v_rcp_f32 v151, v151
    v_rcp_f32 v152, v152
    v_rcp_f32 v153, v153
    v_rcp_f32 v154, v154
    v_rcp_f32 v155, v155
    v_rcp_f32 v156, v156
    v_rcp_f32 v157, v157
    v_mul_f32 v120, v120, v150
    v_mul_f32 v121, v121, v151
    v_mul_f32 v122, v122, v152
    v_mul_f32 v123, v123, v153
    v_mul_f32 v124, v124, v154
    v_mul_f32 v125, v125, v155
    v_mul_f32 v126, v126, v156
    v_mul_f32 v127, v127, v157
    v_cvt_pk_bf16_f32 v120, v120, v121
    v_cvt_pk_bf16_f32 v121, v122, v123
    ds_write_b64 v16, v[120:121] offset:2592
    v_cvt_pk_bf16_f32 v124, v124, v125
    v_cvt_pk_bf16_f32 v125, v126, v127
    ds_write_b64 v16, v[124:125] offset:2608
    v_add_f32 v128, v128, v32
    v_add_f32 v129, v129, v33
    v_add_f32 v130, v130, v34
    v_add_f32 v131, v131, v35
    v_add_f32 v132, v132, v36
    v_add_f32 v133, v133, v37
    v_add_f32 v134, v134, v38
    v_add_f32 v135, v135, v39
    v_mul_f32 v150, v128, v128
    v_mul_f32 v151, v129, v129
    v_mul_f32 v152, v130, v130
    v_mul_f32 v153, v131, v131
    v_mul_f32 v154, v132, v132
    v_mul_f32 v155, v133, v133
    v_mul_f32 v156, v134, v134
    v_mul_f32 v157, v135, v135
    v_fma_f32 v150, v150, s41, v17
    v_fma_f32 v151, v151, s41, v17
    v_fma_f32 v152, v152, s41, v17
    v_fma_f32 v153, v153, s41, v17
    v_fma_f32 v154, v154, s41, v17
    v_fma_f32 v155, v155, s41, v17
    v_fma_f32 v156, v156, s41, v17
    v_fma_f32 v157, v157, s41, v17
    v_mul_f32 v150, v150, v128
    v_mul_f32 v151, v151, v129
    v_mul_f32 v152, v152, v130
    v_mul_f32 v153, v153, v131
    v_mul_f32 v154, v154, v132
    v_mul_f32 v155, v155, v133
    v_mul_f32 v156, v156, v134
    v_mul_f32 v157, v157, v135
    v_exp_f32 v150, v150
    v_exp_f32 v151, v151
    v_exp_f32 v152, v152
    v_exp_f32 v153, v153
    v_exp_f32 v154, v154
    v_exp_f32 v155, v155
    v_exp_f32 v156, v156
    v_exp_f32 v157, v157
    v_add_f32 v150, 1.0, v150
    v_add_f32 v151, 1.0, v151
    v_add_f32 v152, 1.0, v152
    v_add_f32 v153, 1.0, v153
    v_add_f32 v154, 1.0, v154
    v_add_f32 v155, 1.0, v155
    v_add_f32 v156, 1.0, v156
    v_add_f32 v157, 1.0, v157
    v_rcp_f32 v150, v150
    v_rcp_f32 v151, v151
    v_rcp_f32 v152, v152
    v_rcp_f32 v153, v153
    v_rcp_f32 v154, v154
    v_rcp_f32 v155, v155
    v_rcp_f32 v156, v156
    v_rcp_f32 v157, v157
    v_mul_f32 v128, v128, v150
    v_mul_f32 v129, v129, v151
    v_mul_f32 v130, v130, v152
    v_mul_f32 v131, v131, v153
    v_mul_f32 v132, v132, v154
    v_mul_f32 v133, v133, v155
    v_mul_f32 v134, v134, v156
    v_mul_f32 v135, v135, v157
    v_cvt_pk_bf16_f32 v128, v128, v129
    v_cvt_pk_bf16_f32 v129, v130, v131
    ds_write_b64 v16, v[128:129] offset:5120
    v_cvt_pk_bf16_f32 v132, v132, v133
    v_cvt_pk_bf16_f32 v133, v134, v135
    ds_write_b64 v16, v[132:133] offset:5136
    v_add_f32 v136, v136, v40
    v_add_f32 v137, v137, v41
    v_add_f32 v138, v138, v42
    v_add_f32 v139, v139, v43
    v_add_f32 v140, v140, v44
    v_add_f32 v141, v141, v45
    v_add_f32 v142, v142, v46
    v_add_f32 v143, v143, v47
    v_mul_f32 v150, v136, v136
    v_mul_f32 v151, v137, v137
    v_mul_f32 v152, v138, v138
    v_mul_f32 v153, v139, v139
    v_mul_f32 v154, v140, v140
    v_mul_f32 v155, v141, v141
    v_mul_f32 v156, v142, v142
    v_mul_f32 v157, v143, v143
    v_fma_f32 v150, v150, s41, v17
    v_fma_f32 v151, v151, s41, v17
    v_fma_f32 v152, v152, s41, v17
    v_fma_f32 v153, v153, s41, v17
    v_fma_f32 v154, v154, s41, v17
    v_fma_f32 v155, v155, s41, v17
    v_fma_f32 v156, v156, s41, v17
    v_fma_f32 v157, v157, s41, v17
    v_mul_f32 v150, v150, v136
    v_mul_f32 v151, v151, v137
    v_mul_f32 v152, v152, v138
    v_mul_f32 v153, v153, v139
    v_mul_f32 v154, v154, v140
    v_mul_f32 v155, v155, v141
    v_mul_f32 v156, v156, v142
    v_mul_f32 v157, v157, v143
    v_exp_f32 v150, v150
    v_exp_f32 v151, v151
    v_exp_f32 v152, v152
    v_exp_f32 v153, v153
    v_exp_f32 v154, v154
    v_exp_f32 v155, v155
    v_exp_f32 v156, v156
    v_exp_f32 v157, v157
    v_add_f32 v150, 1.0, v150
    v_add_f32 v151, 1.0, v151
    v_add_f32 v152, 1.0, v152
    v_add_f32 v153, 1.0, v153
    v_add_f32 v154, 1.0, v154
    v_add_f32 v155, 1.0, v155
    v_add_f32 v156, 1.0, v156
    v_add_f32 v157, 1.0, v157
    v_rcp_f32 v150, v150
    v_rcp_f32 v151, v151
    v_rcp_f32 v152, v152
    v_rcp_f32 v153, v153
    v_rcp_f32 v154, v154
    v_rcp_f32 v155, v155
    v_rcp_f32 v156, v156
    v_rcp_f32 v157, v157
    v_mul_f32 v136, v136, v150
    v_mul_f32 v137, v137, v151
    v_mul_f32 v138, v138, v152
    v_mul_f32 v139, v139, v153
    v_mul_f32 v140, v140, v154
    v_mul_f32 v141, v141, v155
    v_mul_f32 v142, v142, v156
    v_mul_f32 v143, v143, v157
    v_cvt_pk_bf16_f32 v136, v136, v137
    v_cvt_pk_bf16_f32 v137, v138, v139
    ds_write_b64 v16, v[136:137] offset:5152
    v_cvt_pk_bf16_f32 v140, v140, v141
    v_cvt_pk_bf16_f32 v141, v142, v143
    ds_write_b64 v16, v[140:141] offset:5168
    s_waitcnt lgkmcnt(0)
    ds_read_b128 v[48:51], v18 offset:0
    ds_read_b128 v[52:55], v18 offset:1280
    ds_read_b128 v[56:59], v18 offset:2560
    ds_read_b128 v[60:63], v18 offset:3840
    ds_read_b128 v[64:67], v18 offset:5120
    ds_read_b128 v[68:71], v18 offset:6400
    s_waitcnt lgkmcnt(5)
    buffer_store_dwordx4 v[48:51], v19, s[20:23], s42 offen offset:0
    s_waitcnt lgkmcnt(4)
    buffer_store_dwordx4 v[52:55], v19, s[20:23], s42 offen offset:2048
    s_waitcnt lgkmcnt(3)
    buffer_store_dwordx4 v[56:59], v19, s[20:23], s43 offen offset:0
    s_waitcnt lgkmcnt(2)
    buffer_store_dwordx4 v[60:63], v19, s[20:23], s43 offen offset:2048
    s_waitcnt lgkmcnt(1)
    buffer_store_dwordx4 v[64:67], v19, s[20:23], s44 offen offset:0
    s_waitcnt lgkmcnt(0)
    buffer_store_dwordx4 v[68:71], v19, s[20:23], s44 offen offset:2048
mlp1_kernel_done:
mlp1_kernel_end:
    s_endpgm

.globl mlp2_kernel
.p2align 8
.type mlp2_kernel,@function
mlp2_kernel:
    s_cmp_ge_u32 s2, 256
    s_cbranch_scc1 mlp2_kernel_end
    s_load_dwordx2 s[4:5], s[0:1], 48
    s_load_dwordx2 s[28:29], s[0:1], 80
    v_and_b32 v1, 63, v0
    v_lshrrev_b32 v2, 4, v1
    v_and_b32 v3, 15, v1
    v_lshrrev_b32 v4, 6, v0
    s_nop 1
    v_readfirstlane_b32 s26, v4
    s_and_b32 s24, s2, 7
    s_lshl_b32 s24, s24, 5
    s_lshr_b32 s25, s2, 3
    s_add_u32 s27, s24, s25
    s_and_b32 s24, s27, 3
    s_lshr_b32 s25, s27, 2
    s_and_b32 s25, s25, 15
    s_lshr_b32 s27, s27, 6
    s_waitcnt lgkmcnt(0)
    s_mov_b32 s8, s4
    s_mov_b32 s9, s5
    s_mov_b32 s10, 18874368
    s_mov_b32 s11, 0x00020000
    s_add_u32 s16, s28, 16777216
    s_addc_u32 s17, s29, 0
    s_mov_b32 s18, 5308416
    s_mov_b32 s19, 0x00020000
    s_add_u32 s20, s28, 25165824
    s_addc_u32 s21, s29, 0
    s_mov_b32 s22, 18874368
    s_mov_b32 s23, 0x00020000
    s_cmp_ge_u32 s26, 4
    s_cbranch_scc0 mlp2_kernel_cons
    s_sub_u32 s26, s26, 4
    s_lshl_b32 s30, s26, 2
    v_add_u32 v10, s30, v2
    v_and_b32 v10, 7, v10
    v_and_b32 v11, 7, v1
    v_xor_b32 v10, v10, v11
    v_lshrrev_b32 v11, 3, v1
    v_lshlrev_b32 v11, 7, v11
    v_lshl_add_u32 v5, v10, 4, v11
    s_and_b32 s30, s26, 1
    s_add_u32 s45, s30, 16
    s_lshl_b32 s45, s45, 10
    s_lshl_b32 s46, s26, 10
    s_lshl_b32 s30, s26, 4
    v_add_u32 v10, s30, v2
    v_lshlrev_b32 v10, 12, v10
    s_lshl_b32 s30, s25, 8
    v_add_u32 v10, s30, v10
    v_lshlrev_b32 v11, 1, v2
    v_xor_b32 v11, v11, v3
    v_lshl_add_u32 v6, v11, 4, v10
    v_xor_b32 v11, 8, v11
    v_lshl_add_u32 v7, v11, 4, v10
    s_lshl_b32 s32, s26, 12
    s_add_u32 s32, s32, 18432
    s_mul_i32 s35, s27, 1327104
    s_mul_i32 s30, s24, 18432
    s_add_u32 s35, s35, s30
    s_mul_i32 s36, s27, 4718592
    s_mov_b32 s34, 0
    s_add_u32 s37, s34, s46
    s_add_u32 s47, s35, s46
    s_add_u32 m0, s37, 0
    s_add_u32 s38, s47, 0
    buffer_load_dwordx4 v5, s[16:19], s38 offen lds
    s_add_u32 m0, s37, 4096
    s_add_u32 s38, s47, 4096
    buffer_load_dwordx4 v5, s[16:19], s38 offen lds
    s_add_u32 m0, s37, 8192
    s_add_u32 s38, s47, 8192
    buffer_load_dwordx4 v5, s[16:19], s38 offen lds
    s_add_u32 m0, s37, 12288
    s_add_u32 s38, s47, 12288
    buffer_load_dwordx4 v5, s[16:19], s38 offen lds
    s_add_u32 m0, s34, s45
    s_add_u32 s38, s35, s45
    buffer_load_dwordx4 v5, s[16:19], s38 offen lds
    s_add_u32 s37, s34, s32
    s_add_u32 m0, s37, 0
    s_add_u32 s38, s36, 0
    buffer_load_dwordx4 v6, s[8:11], s38 offen lds
    s_add_u32 m0, s37, 1024
    s_add_u32 s38, s36, 16384
    buffer_load_dwordx4 v6, s[8:11], s38 offen lds
    s_add_u32 m0, s37, 2048
    s_add_u32 s38, s36, 32768
    buffer_load_dwordx4 v7, s[8:11], s38 offen lds
    s_add_u32 m0, s37, 3072
    s_add_u32 s38, s36, 49152
    buffer_load_dwordx4 v7, s[8:11], s38 offen lds
    s_add_u32 s35, s35, 73728
    s_add_u32 s36, s36, 262144
    s_add_u32 s34, s34, 34816
    s_cmp_eq_u32 s34, 139264
    s_cselect_b32 s34, 0, s34
    s_add_u32 s37, s34, s46
    s_add_u32 s47, s35, s46
    s_add_u32 m0, s37, 0
    s_add_u32 s38, s47, 0
    buffer_load_dwordx4 v5, s[16:19], s38 offen lds
    s_add_u32 m0, s37, 4096
    s_add_u32 s38, s47, 4096
    buffer_load_dwordx4 v5, s[16:19], s38 offen lds
    s_add_u32 m0, s37, 8192
    s_add_u32 s38, s47, 8192
    buffer_load_dwordx4 v5, s[16:19], s38 offen lds
    s_add_u32 m0, s37, 12288
    s_add_u32 s38, s47, 12288
    buffer_load_dwordx4 v5, s[16:19], s38 offen lds
    s_add_u32 m0, s34, s45
    s_add_u32 s38, s35, s45
    buffer_load_dwordx4 v5, s[16:19], s38 offen lds
    s_add_u32 s37, s34, s32
    s_add_u32 m0, s37, 0
    s_add_u32 s38, s36, 0
    buffer_load_dwordx4 v6, s[8:11], s38 offen lds
    s_add_u32 m0, s37, 1024
    s_add_u32 s38, s36, 16384
    buffer_load_dwordx4 v6, s[8:11], s38 offen lds
    s_add_u32 m0, s37, 2048
    s_add_u32 s38, s36, 32768
    buffer_load_dwordx4 v7, s[8:11], s38 offen lds
    s_add_u32 m0, s37, 3072
    s_add_u32 s38, s36, 49152
    buffer_load_dwordx4 v7, s[8:11], s38 offen lds
    s_add_u32 s35, s35, 73728
    s_add_u32 s36, s36, 262144
    s_add_u32 s34, s34, 34816
    s_cmp_eq_u32 s34, 139264
    s_cselect_b32 s34, 0, s34
    s_add_u32 s37, s34, s46
    s_add_u32 s47, s35, s46
    s_add_u32 m0, s37, 0
    s_add_u32 s38, s47, 0
    buffer_load_dwordx4 v5, s[16:19], s38 offen lds
    s_add_u32 m0, s37, 4096
    s_add_u32 s38, s47, 4096
    buffer_load_dwordx4 v5, s[16:19], s38 offen lds
    s_add_u32 m0, s37, 8192
    s_add_u32 s38, s47, 8192
    buffer_load_dwordx4 v5, s[16:19], s38 offen lds
    s_add_u32 m0, s37, 12288
    s_add_u32 s38, s47, 12288
    buffer_load_dwordx4 v5, s[16:19], s38 offen lds
    s_add_u32 m0, s34, s45
    s_add_u32 s38, s35, s45
    buffer_load_dwordx4 v5, s[16:19], s38 offen lds
    s_add_u32 s37, s34, s32
    s_add_u32 m0, s37, 0
    s_add_u32 s38, s36, 0
    buffer_load_dwordx4 v6, s[8:11], s38 offen lds
    s_add_u32 m0, s37, 1024
    s_add_u32 s38, s36, 16384
    buffer_load_dwordx4 v6, s[8:11], s38 offen lds
    s_add_u32 m0, s37, 2048
    s_add_u32 s38, s36, 32768
    buffer_load_dwordx4 v7, s[8:11], s38 offen lds
    s_add_u32 m0, s37, 3072
    s_add_u32 s38, s36, 49152
    buffer_load_dwordx4 v7, s[8:11], s38 offen lds
    s_add_u32 s35, s35, 73728
    s_add_u32 s36, s36, 262144
    s_add_u32 s34, s34, 34816
    s_cmp_eq_u32 s34, 139264
    s_cselect_b32 s34, 0, s34
    s_waitcnt vmcnt(18)
    s_barrier
    s_mov_b32 s40, 0
mlp2_kernel_lloop:
    s_waitcnt vmcnt(9)
    s_barrier
    s_add_u32 s37, s34, s46
    s_add_u32 s47, s35, s46
    s_add_u32 m0, s37, 0
    s_add_u32 s38, s47, 0
    buffer_load_dwordx4 v5, s[16:19], s38 offen lds
    s_add_u32 m0, s37, 4096
    s_add_u32 s38, s47, 4096
    buffer_load_dwordx4 v5, s[16:19], s38 offen lds
    s_add_u32 m0, s37, 8192
    s_add_u32 s38, s47, 8192
    buffer_load_dwordx4 v5, s[16:19], s38 offen lds
    s_add_u32 m0, s37, 12288
    s_add_u32 s38, s47, 12288
    buffer_load_dwordx4 v5, s[16:19], s38 offen lds
    s_add_u32 m0, s34, s45
    s_add_u32 s38, s35, s45
    buffer_load_dwordx4 v5, s[16:19], s38 offen lds
    s_add_u32 s37, s34, s32
    s_add_u32 m0, s37, 0
    s_add_u32 s38, s36, 0
    buffer_load_dwordx4 v6, s[8:11], s38 offen lds
    s_add_u32 m0, s37, 1024
    s_add_u32 s38, s36, 16384
    buffer_load_dwordx4 v6, s[8:11], s38 offen lds
    s_add_u32 m0, s37, 2048
    s_add_u32 s38, s36, 32768
    buffer_load_dwordx4 v7, s[8:11], s38 offen lds
    s_add_u32 m0, s37, 3072
    s_add_u32 s38, s36, 49152
    buffer_load_dwordx4 v7, s[8:11], s38 offen lds
    s_add_u32 s35, s35, 73728
    s_add_u32 s36, s36, 262144
    s_add_u32 s34, s34, 34816
    s_cmp_eq_u32 s34, 139264
    s_cselect_b32 s34, 0, s34
    s_add_u32 s40, s40, 1
    s_cmp_lt_u32 s40, 15
    s_cbranch_scc1 mlp2_kernel_lloop
    s_waitcnt vmcnt(9)
    s_barrier
    s_waitcnt vmcnt(0)
    s_barrier
    s_waitcnt vmcnt(0)
    s_barrier
    s_endpgm
mlp2_kernel_cons:
    v_lshrrev_b32 v200, 1, v3
    v_xor_b32 v201, v2, v200
    v_lshlrev_b32 v202, 7, v3
    v_lshl_add_u32 v8, v201, 4, v202
    v_xor_b32 v201, 4, v201
    v_lshl_add_u32 v9, v201, 4, v202
    v_lshrrev_b32 v200, 2, v3
    v_and_b32 v201, 3, v3
    v_lshl_add_u32 v202, v2, 3, v200
    v_and_b32 v203, 1, v2
    v_lshl_add_u32 v203, v203, 2, v200
    v_lshlrev_b32 v203, 1, v203
    v_lshrrev_b32 v204, 1, v201
    s_lshl_b32 s30, s26, 2
    v_add_u32 v204, s30, v204
    v_xor_b32 v205, v204, v203
    v_lshlrev_b32 v205, 4, v205
    v_lshl_add_u32 v205, v202, 8, v205
    v_and_b32 v206, 1, v201
    v_lshl_add_u32 v205, v206, 3, v205
    v_add_u32 v10, 18432, v205
    v_xor_b32 v11, 32, v10
    v_mov_b32 v112, 0
    v_mov_b32 v113, 0
    v_mov_b32 v114, 0
    v_mov_b32 v115, 0
    v_mov_b32 v116, 0
    v_mov_b32 v117, 0
    v_mov_b32 v118, 0
    v_mov_b32 v119, 0
    v_mov_b32 v120, 0
    v_mov_b32 v121, 0
    v_mov_b32 v122, 0
    v_mov_b32 v123, 0
    v_mov_b32 v124, 0
    v_mov_b32 v125, 0
    v_mov_b32 v126, 0
    v_mov_b32 v127, 0
    v_mov_b32 v128, 0
    v_mov_b32 v129, 0
    v_mov_b32 v130, 0
    v_mov_b32 v131, 0
    v_mov_b32 v132, 0
    v_mov_b32 v133, 0
    v_mov_b32 v134, 0
    v_mov_b32 v135, 0
    v_mov_b32 v136, 0
    v_mov_b32 v137, 0
    v_mov_b32 v138, 0
    v_mov_b32 v139, 0
    v_mov_b32 v140, 0
    v_mov_b32 v141, 0
    v_mov_b32 v142, 0
    v_mov_b32 v143, 0
    v_mov_b32 v144, 0
    v_mov_b32 v145, 0
    v_mov_b32 v146, 0
    v_mov_b32 v147, 0
    v_mov_b32 v148, 0
    v_mov_b32 v149, 0
    v_mov_b32 v150, 0
    v_mov_b32 v151, 0
    v_mov_b32 v152, 0
    v_mov_b32 v153, 0
    v_mov_b32 v154, 0
    v_mov_b32 v155, 0
    v_mov_b32 v156, 0
    v_mov_b32 v157, 0
    v_mov_b32 v158, 0
    v_mov_b32 v159, 0
    v_mov_b32 v160, 0
    v_mov_b32 v161, 0
    v_mov_b32 v162, 0
    v_mov_b32 v163, 0
    v_mov_b32 v164, 0
    v_mov_b32 v165, 0
    v_mov_b32 v166, 0
    v_mov_b32 v167, 0
    v_mov_b32 v168, 0
    v_mov_b32 v169, 0
    v_mov_b32 v170, 0
    v_mov_b32 v171, 0
    v_mov_b32 v172, 0
    v_mov_b32 v173, 0
    v_mov_b32 v174, 0
    v_mov_b32 v175, 0
    v_mov_b32 v176, 0
    v_mov_b32 v177, 0
    v_mov_b32 v178, 0
    v_mov_b32 v179, 0
    v_mov_b32 v180, 0
    v_mov_b32 v181, 0
    v_mov_b32 v182, 0
    v_mov_b32 v183, 0
    v_mov_b32 v12, v8
    v_mov_b32 v16, v8
    v_mov_b32 v13, v9
    v_mov_b32 v17, v9
    v_mov_b32 v14, v10
    v_mov_b32 v18, v10
    v_mov_b32 v15, v11
    v_mov_b32 v19, v11
    s_mov_b32 s39, 0
    s_mov_b32 s40, 0
    s_barrier
    ds_read_b64_tr_b16 v[96:97], v18 offset:0
    ds_read_b64_tr_b16 v[98:99], v18 offset:1024
    ds_read_b64_tr_b16 v[100:101], v19 offset:0
    ds_read_b64_tr_b16 v[102:103], v19 offset:1024
    ds_read_b128 v[24:27], v16 offset:0
    ds_read_b128 v[28:31], v16 offset:2048
    ds_read_b128 v[32:35], v16 offset:4096
    ds_read_b128 v[36:39], v16 offset:6144
    ds_read_b128 v[40:43], v16 offset:8192
    ds_read_b128 v[44:47], v16 offset:10240
    ds_read_b128 v[48:51], v16 offset:12288
    ds_read_b128 v[52:55], v16 offset:14336
    ds_read_b128 v[56:59], v16 offset:16384
mlp2_kernel_loop0:
    s_add_u32 s39, s39, 34816
    s_cmp_eq_u32 s39, 139264
    s_cselect_b32 s39, 0, s39
    v_mov_b32 v12, v16
    v_add_u32 v16, s39, v8
    v_mov_b32 v13, v17
    v_add_u32 v17, s39, v9
    v_mov_b32 v14, v18
    v_add_u32 v18, s39, v10
    v_mov_b32 v15, v19
    v_add_u32 v19, s39, v11
    s_waitcnt lgkmcnt(6)
    v_mfma_f32_16x16x32_bf16 v[112:115], v[24:27], v[96:99], v[112:115]
    ds_read_b64_tr_b16 v[104:105], v14 offset:8192
    v_mfma_f32_16x16x32_bf16 v[116:119], v[24:27], v[100:103], v[116:119]
    ds_read_b64_tr_b16 v[106:107], v14 offset:9216
    v_mfma_f32_16x16x32_bf16 v[120:123], v[28:31], v[96:99], v[120:123]
    ds_read_b64_tr_b16 v[108:109], v15 offset:8192
    v_mfma_f32_16x16x32_bf16 v[124:127], v[28:31], v[100:103], v[124:127]
    ds_read_b64_tr_b16 v[110:111], v15 offset:9216
    v_mfma_f32_16x16x32_bf16 v[128:131], v[32:35], v[96:99], v[128:131]
    ds_read_b128 v[60:63], v13 offset:0
    v_mfma_f32_16x16x32_bf16 v[132:135], v[32:35], v[100:103], v[132:135]
    ds_read_b128 v[64:67], v13 offset:2048
    s_waitcnt lgkmcnt(9)
    v_mfma_f32_16x16x32_bf16 v[136:139], v[36:39], v[96:99], v[136:139]
    ds_read_b128 v[68:71], v13 offset:4096
    v_mfma_f32_16x16x32_bf16 v[140:143], v[36:39], v[100:103], v[140:143]
    ds_read_b128 v[72:75], v13 offset:6144
    v_mfma_f32_16x16x32_bf16 v[144:147], v[40:43], v[96:99], v[144:147]
    ds_read_b128 v[76:79], v13 offset:8192
    v_mfma_f32_16x16x32_bf16 v[148:151], v[40:43], v[100:103], v[148:151]
    ds_read_b128 v[80:83], v13 offset:10240
    v_mfma_f32_16x16x32_bf16 v[152:155], v[44:47], v[96:99], v[152:155]
    ds_read_b128 v[84:87], v13 offset:12288
    v_mfma_f32_16x16x32_bf16 v[156:159], v[44:47], v[100:103], v[156:159]
    ds_read_b128 v[88:91], v13 offset:14336
    s_waitcnt lgkmcnt(12)
    v_mfma_f32_16x16x32_bf16 v[160:163], v[48:51], v[96:99], v[160:163]
    ds_read_b128 v[92:95], v13 offset:16384
    v_mfma_f32_16x16x32_bf16 v[164:167], v[48:51], v[100:103], v[164:167]
    v_mfma_f32_16x16x32_bf16 v[168:171], v[52:55], v[96:99], v[168:171]
    v_mfma_f32_16x16x32_bf16 v[172:175], v[52:55], v[100:103], v[172:175]
    v_mfma_f32_16x16x32_bf16 v[176:179], v[56:59], v[96:99], v[176:179]
    v_mfma_f32_16x16x32_bf16 v[180:183], v[56:59], v[100:103], v[180:183]
    s_barrier
    s_waitcnt lgkmcnt(6)
    v_mfma_f32_16x16x32_bf16 v[112:115], v[60:63], v[104:107], v[112:115]
    ds_read_b64_tr_b16 v[96:97], v18 offset:0
    v_mfma_f32_16x16x32_bf16 v[116:119], v[60:63], v[108:111], v[116:119]
    ds_read_b64_tr_b16 v[98:99], v18 offset:1024
    v_mfma_f32_16x16x32_bf16 v[120:123], v[64:67], v[104:107], v[120:123]
    ds_read_b64_tr_b16 v[100:101], v19 offset:0
    v_mfma_f32_16x16x32_bf16 v[124:127], v[64:67], v[108:111], v[124:127]
    ds_read_b64_tr_b16 v[102:103], v19 offset:1024
    v_mfma_f32_16x16x32_bf16 v[128:131], v[68:71], v[104:107], v[128:131]
    ds_read_b128 v[24:27], v16 offset:0
    v_mfma_f32_16x16x32_bf16 v[132:135], v[68:71], v[108:111], v[132:135]
    ds_read_b128 v[28:31], v16 offset:2048
    s_waitcnt lgkmcnt(9)
    v_mfma_f32_16x16x32_bf16 v[136:139], v[72:75], v[104:107], v[136:139]
    ds_read_b128 v[32:35], v16 offset:4096
    v_mfma_f32_16x16x32_bf16 v[140:143], v[72:75], v[108:111], v[140:143]
    ds_read_b128 v[36:39], v16 offset:6144
    v_mfma_f32_16x16x32_bf16 v[144:147], v[76:79], v[104:107], v[144:147]
    ds_read_b128 v[40:43], v16 offset:8192
    v_mfma_f32_16x16x32_bf16 v[148:151], v[76:79], v[108:111], v[148:151]
    ds_read_b128 v[44:47], v16 offset:10240
    v_mfma_f32_16x16x32_bf16 v[152:155], v[80:83], v[104:107], v[152:155]
    ds_read_b128 v[48:51], v16 offset:12288
    v_mfma_f32_16x16x32_bf16 v[156:159], v[80:83], v[108:111], v[156:159]
    ds_read_b128 v[52:55], v16 offset:14336
    s_waitcnt lgkmcnt(12)
    v_mfma_f32_16x16x32_bf16 v[160:163], v[84:87], v[104:107], v[160:163]
    ds_read_b128 v[56:59], v16 offset:16384
    v_mfma_f32_16x16x32_bf16 v[164:167], v[84:87], v[108:111], v[164:167]
    v_mfma_f32_16x16x32_bf16 v[168:171], v[88:91], v[104:107], v[168:171]
    v_mfma_f32_16x16x32_bf16 v[172:175], v[88:91], v[108:111], v[172:175]
    v_mfma_f32_16x16x32_bf16 v[176:179], v[92:95], v[104:107], v[176:179]
    v_mfma_f32_16x16x32_bf16 v[180:183], v[92:95], v[108:111], v[180:183]
    s_add_u32 s40, s40, 1
    s_cmp_lt_u32 s40, 18
    s_cbranch_scc1 mlp2_kernel_loop0
    s_waitcnt lgkmcnt(0)
    s_barrier
    s_mul_i32 s47, s26, 9728
    v_mul_u32_u24 v200, 304, v3
    v_lshl_add_u32 v200, v2, 3, v200
    v_add_u32 v200, s47, v200
    v_cvt_pk_bf16_f32 v112, v112, v113
    v_cvt_pk_bf16_f32 v113, v114, v115
    ds_write_b64 v200, v[112:113] offset:0
    v_cvt_pk_bf16_f32 v116, v116, v117
    v_cvt_pk_bf16_f32 v117, v118, v119
    ds_write_b64 v200, v[116:117] offset:4864
    v_cvt_pk_bf16_f32 v120, v120, v121
    v_cvt_pk_bf16_f32 v121, v122, v123
    ds_write_b64 v200, v[120:121] offset:32
    v_cvt_pk_bf16_f32 v124, v124, v125
    v_cvt_pk_bf16_f32 v125, v126, v127
    ds_write_b64 v200, v[124:125] offset:4896
    v_cvt_pk_bf16_f32 v128, v128, v129
    v_cvt_pk_bf16_f32 v129, v130, v131
    ds_write_b64 v200, v[128:129] offset:64
    v_cvt_pk_bf16_f32 v132, v132, v133
    v_cvt_pk_bf16_f32 v133, v134, v135
    ds_write_b64 v200, v[132:133] offset:4928
    v_cvt_pk_bf16_f32 v136, v136, v137
    v_cvt_pk_bf16_f32 v137, v138, v139
    ds_write_b64 v200, v[136:137] offset:96
    v_cvt_pk_bf16_f32 v140, v140, v141
    v_cvt_pk_bf16_f32 v141, v142, v143
    ds_write_b64 v200, v[140:141] offset:4960
    v_cvt_pk_bf16_f32 v144, v144, v145
    v_cvt_pk_bf16_f32 v145, v146, v147
    ds_write_b64 v200, v[144:145] offset:128
    v_cvt_pk_bf16_f32 v148, v148, v149
    v_cvt_pk_bf16_f32 v149, v150, v151
    ds_write_b64 v200, v[148:149] offset:4992
    v_cvt_pk_bf16_f32 v152, v152, v153
    v_cvt_pk_bf16_f32 v153, v154, v155
    ds_write_b64 v200, v[152:153] offset:160
    v_cvt_pk_bf16_f32 v156, v156, v157
    v_cvt_pk_bf16_f32 v157, v158, v159
    ds_write_b64 v200, v[156:157] offset:5024
    v_cvt_pk_bf16_f32 v160, v160, v161
    v_cvt_pk_bf16_f32 v161, v162, v163
    ds_write_b64 v200, v[160:161] offset:192
    v_cvt_pk_bf16_f32 v164, v164, v165
    v_cvt_pk_bf16_f32 v165, v166, v167
    ds_write_b64 v200, v[164:165] offset:5056
    v_cvt_pk_bf16_f32 v168, v168, v169
    v_cvt_pk_bf16_f32 v169, v170, v171
    ds_write_b64 v200, v[168:169] offset:224
    v_cvt_pk_bf16_f32 v172, v172, v173
    v_cvt_pk_bf16_f32 v173, v174, v175
    ds_write_b64 v200, v[172:173] offset:5088
    v_cvt_pk_bf16_f32 v176, v176, v177
    v_cvt_pk_bf16_f32 v177, v178, v179
    ds_write_b64 v200, v[176:177] offset:256
    v_cvt_pk_bf16_f32 v180, v180, v181
    v_cvt_pk_bf16_f32 v181, v182, v183
    ds_write_b64 v200, v[180:181] offset:5120
    s_lshl_b32 s30, s27, 11
    s_lshl_b32 s31, s25, 7
    s_add_u32 s30, s30, s31
    s_lshl_b32 s31, s26, 5
    s_add_u32 s30, s30, s31
    s_mul_i32 s30, s30, 1152
    s_mul_i32 s31, s24, 288
    s_add_u32 s30, s30, s31
    v_add_u32 v201, 0, v1
    v_mul_u32_u24 v202, 3641, v201
    v_lshrrev_b32 v202, 16, v202
    v_mul_u32_u24 v203, 18, v202
    v_sub_u32 v203, v201, v203
    v_lshlrev_b32 v203, 4, v203
    v_mul_u32_u24 v204, 304, v202
    v_add3_u32 v24, v204, v203, s47
    v_mul_u32_u24 v204, 1152, v202
    v_add_u32 v40, v204, v203
    v_add_u32 v201, 64, v1
    v_mul_u32_u24 v202, 3641, v201
    v_lshrrev_b32 v202, 16, v202
    v_mul_u32_u24 v203, 18, v202
    v_sub_u32 v203, v201, v203
    v_lshlrev_b32 v203, 4, v203
    v_mul_u32_u24 v204, 304, v202
    v_add3_u32 v25, v204, v203, s47
    v_mul_u32_u24 v204, 1152, v202
    v_add_u32 v41, v204, v203
    v_add_u32 v201, 128, v1
    v_mul_u32_u24 v202, 3641, v201
    v_lshrrev_b32 v202, 16, v202
    v_mul_u32_u24 v203, 18, v202
    v_sub_u32 v203, v201, v203
    v_lshlrev_b32 v203, 4, v203
    v_mul_u32_u24 v204, 304, v202
    v_add3_u32 v26, v204, v203, s47
    v_mul_u32_u24 v204, 1152, v202
    v_add_u32 v42, v204, v203
    v_add_u32 v201, 192, v1
    v_mul_u32_u24 v202, 3641, v201
    v_lshrrev_b32 v202, 16, v202
    v_mul_u32_u24 v203, 18, v202
    v_sub_u32 v203, v201, v203
    v_lshlrev_b32 v203, 4, v203
    v_mul_u32_u24 v204, 304, v202
    v_add3_u32 v27, v204, v203, s47
    v_mul_u32_u24 v204, 1152, v202
    v_add_u32 v43, v204, v203
    v_add_u32 v201, 256, v1
    v_mul_u32_u24 v202, 3641, v201
    v_lshrrev_b32 v202, 16, v202
    v_mul_u32_u24 v203, 18, v202
    v_sub_u32 v203, v201, v203
    v_lshlrev_b32 v203, 4, v203
    v_mul_u32_u24 v204, 304, v202
    v_add3_u32 v28, v204, v203, s47
    v_mul_u32_u24 v204, 1152, v202
    v_add_u32 v44, v204, v203
    v_add_u32 v201, 320, v1
    v_mul_u32_u24 v202, 3641, v201
    v_lshrrev_b32 v202, 16, v202
    v_mul_u32_u24 v203, 18, v202
    v_sub_u32 v203, v201, v203
    v_lshlrev_b32 v203, 4, v203
    v_mul_u32_u24 v204, 304, v202
    v_add3_u32 v29, v204, v203, s47
    v_mul_u32_u24 v204, 1152, v202
    v_add_u32 v45, v204, v203
    v_add_u32 v201, 384, v1
    v_mul_u32_u24 v202, 3641, v201
    v_lshrrev_b32 v202, 16, v202
    v_mul_u32_u24 v203, 18, v202
    v_sub_u32 v203, v201, v203
    v_lshlrev_b32 v203, 4, v203
    v_mul_u32_u24 v204, 304, v202
    v_add3_u32 v30, v204, v203, s47
    v_mul_u32_u24 v204, 1152, v202
    v_add_u32 v46, v204, v203
    v_add_u32 v201, 448, v1
    v_mul_u32_u24 v202, 3641, v201
    v_lshrrev_b32 v202, 16, v202
    v_mul_u32_u24 v203, 18, v202
    v_sub_u32 v203, v201, v203
    v_lshlrev_b32 v203, 4, v203
    v_mul_u32_u24 v204, 304, v202
    v_add3_u32 v31, v204, v203, s47
    v_mul_u32_u24 v204, 1152, v202
    v_add_u32 v47, v204, v203
    v_add_u32 v201, 512, v1
    v_mul_u32_u24 v202, 3641, v201
    v_lshrrev_b32 v202, 16, v202
    v_mul_u32_u24 v203, 18, v202
    v_sub_u32 v203, v201, v203
    v_lshlrev_b32 v203, 4, v203
    v_mul_u32_u24 v204, 304, v202
    v_add3_u32 v32, v204, v203, s47
    v_mul_u32_u24 v204, 1152, v202
    v_add_u32 v48, v204, v203
    s_waitcnt lgkmcnt(0)
    ds_read_b128 v[56:59], v24
    ds_read_b128 v[60:63], v25
    ds_read_b128 v[64:67], v26
    ds_read_b128 v[68:71], v27
    ds_read_b128 v[72:75], v28
    ds_read_b128 v[76:79], v29
    ds_read_b128 v[80:83], v30
    ds_read_b128 v[84:87], v31
    ds_read_b128 v[88:91], v32
    s_waitcnt lgkmcnt(8)
    buffer_store_dwordx4 v[56:59], v40, s[20:23], s30 offen
    s_waitcnt lgkmcnt(7)
    buffer_store_dwordx4 v[60:63], v41, s[20:23], s30 offen
    s_waitcnt lgkmcnt(6)
    buffer_store_dwordx4 v[64:67], v42, s[20:23], s30 offen
    s_waitcnt lgkmcnt(5)
    buffer_store_dwordx4 v[68:71], v43, s[20:23], s30 offen
    s_waitcnt lgkmcnt(4)
    buffer_store_dwordx4 v[72:75], v44, s[20:23], s30 offen
    s_waitcnt lgkmcnt(3)
    buffer_store_dwordx4 v[76:79], v45, s[20:23], s30 offen
    s_waitcnt lgkmcnt(2)
    buffer_store_dwordx4 v[80:83], v46, s[20:23], s30 offen
    s_waitcnt lgkmcnt(1)
    buffer_store_dwordx4 v[84:87], v47, s[20:23], s30 offen
    s_waitcnt lgkmcnt(0)
    buffer_store_dwordx4 v[88:91], v48, s[20:23], s30 offen
mlp2_kernel_done:
mlp2_kernel_end:
    s_endpgm

.globl final_kernel
.p2align 8
.type final_kernel,@function
final_kernel:
    s_cmp_ge_u32 s2, 576
    s_cbranch_scc1 final_kernel_end
    s_load_dwordx2 s[4:5], s[0:1], 56
    s_load_dwordx2 s[6:7], s[0:1], 64
    s_load_dwordx2 s[28:29], s[0:1], 80
    s_lshl_b32 s3, s2, 8
    v_add_u32 v1, s3, v0
    v_lshlrev_b32 v2, 4, v1
    s_mov_b32 s30, 0x38e38e4
    v_mul_hi_u32 v4, v1, s30
    v_mul_u32_u24 v12, 72, v4
    v_sub_u32 v12, v1, v12
    v_mul_u32_u24 v13, 43691, v12
    v_lshrrev_b32 v13, 19, v13
    v_mul_u32_u24 v14, 12, v13
    v_sub_u32 v12, v12, v14
    s_mov_b32 s31, 393216
    v_mul_lo_u32 v13, v13, s31
    v_mul_u32_u24 v14, 192, v4
    v_add_u32 v13, v13, v14
    v_lshl_add_u32 v12, v12, 4, v13
    v_lshlrev_b32 v4, 1, v4
    s_waitcnt lgkmcnt(0)
    s_mov_b32 s8, s4
    s_mov_b32 s9, s5
    s_mov_b32 s10, 4096
    s_mov_b32 s11, 0x00020000
    s_mov_b32 s12, s6
    s_mov_b32 s13, s7
    s_mov_b32 s14, 2359296
    s_mov_b32 s15, 0x00020000
    s_add_u32 s16, s28, 11010048
    s_addc_u32 s17, s29, 0
    s_mov_b32 s18, 2359296
    s_mov_b32 s19, 0x00020000
    s_add_u32 s20, s28, 25165824
    s_addc_u32 s21, s29, 0
    s_mov_b32 s22, 18874368
    s_mov_b32 s23, 0x00020000
    s_mov_b32 s32, 0
    buffer_load_dwordx4 v[16:19], v2, s[20:23], s32 offen
    s_mov_b32 s33, 2359296
    buffer_load_dwordx4 v[20:23], v2, s[20:23], s33 offen
    s_mov_b32 s34, 4718592
    buffer_load_dwordx4 v[24:27], v2, s[20:23], s34 offen
    s_mov_b32 s35, 7077888
    buffer_load_dwordx4 v[28:31], v2, s[20:23], s35 offen
    buffer_load_dwordx4 v[32:35], v12, s[16:19], 0 offen
    buffer_load_ushort v5, v4, s[8:11], 0 offen
    v_mov_b32 v10, 0x00003f80
    v_mov_b32 v11, 0x3f800000
    s_waitcnt vmcnt(0)
    v_lshlrev_b32 v40, 16, v5
    v_lshlrev_b32 v41, 16, v5
    v_lshlrev_b32 v42, 16, v5
    v_lshlrev_b32 v43, 16, v5
    v_lshlrev_b32 v44, 16, v5
    v_lshlrev_b32 v45, 16, v5
    v_lshlrev_b32 v46, 16, v5
    v_lshlrev_b32 v47, 16, v5
    v_dot2c_f32_bf16 v40, v16, v10
    v_dot2c_f32_bf16 v41, v16, v11
    v_dot2c_f32_bf16 v42, v17, v10
    v_dot2c_f32_bf16 v43, v17, v11
    v_dot2c_f32_bf16 v44, v18, v10
    v_dot2c_f32_bf16 v45, v18, v11
    v_dot2c_f32_bf16 v46, v19, v10
    v_dot2c_f32_bf16 v47, v19, v11
    v_dot2c_f32_bf16 v40, v20, v10
    v_dot2c_f32_bf16 v41, v20, v11
    v_dot2c_f32_bf16 v42, v21, v10
    v_dot2c_f32_bf16 v43, v21, v11
    v_dot2c_f32_bf16 v44, v22, v10
    v_dot2c_f32_bf16 v45, v22, v11
    v_dot2c_f32_bf16 v46, v23, v10
    v_dot2c_f32_bf16 v47, v23, v11
    v_dot2c_f32_bf16 v40, v24, v10
    v_dot2c_f32_bf16 v41, v24, v11
    v_dot2c_f32_bf16 v42, v25, v10
    v_dot2c_f32_bf16 v43, v25, v11
    v_dot2c_f32_bf16 v44, v26, v10
    v_dot2c_f32_bf16 v45, v26, v11
    v_dot2c_f32_bf16 v46, v27, v10
    v_dot2c_f32_bf16 v47, v27, v11
    v_dot2c_f32_bf16 v40, v28, v10
    v_dot2c_f32_bf16 v41, v28, v11
    v_dot2c_f32_bf16 v42, v29, v10
    v_dot2c_f32_bf16 v43, v29, v11
    v_dot2c_f32_bf16 v44, v30, v10
    v_dot2c_f32_bf16 v45, v30, v11
    v_dot2c_f32_bf16 v46, v31, v10
    v_dot2c_f32_bf16 v47, v31, v11
    v_dot2c_f32_bf16 v40, v32, v10
    v_dot2c_f32_bf16 v41, v32, v11
    v_dot2c_f32_bf16 v42, v33, v10
    v_dot2c_f32_bf16 v43, v33, v11
    v_dot2c_f32_bf16 v44, v34, v10
    v_dot2c_f32_bf16 v45, v34, v11
    v_dot2c_f32_bf16 v46, v35, v10
    v_dot2c_f32_bf16 v47, v35, v11
    s_nop 2
    v_cvt_pk_bf16_f32 v16, v40, v41
    v_cvt_pk_bf16_f32 v17, v42, v43
    v_cvt_pk_bf16_f32 v18, v44, v45
    v_cvt_pk_bf16_f32 v19, v46, v47
    buffer_store_dwordx4 v[16:19], v2, s[12:15], 0 offen
final_kernel_end:
    s_endpgm
code_end:
.section .rodata,"a"
.p2align 6
.amdhsa_kernel qkv_kernel
  .amdhsa_next_free_vgpr 256
  .amdhsa_next_free_sgpr 96
  .amdhsa_accum_offset 256
  .amdhsa_group_segment_fixed_size 0
  .amdhsa_kernarg_size 88
  .amdhsa_user_sgpr_count 2
  .amdhsa_user_sgpr_kernarg_segment_ptr 1
  .amdhsa_system_sgpr_workgroup_id_x 1
.end_amdhsa_kernel

.p2align 6
.amdhsa_kernel attn_kernel
  .amdhsa_next_free_vgpr 144
  .amdhsa_next_free_sgpr 96
  .amdhsa_accum_offset 144
  .amdhsa_group_segment_fixed_size 0
  .amdhsa_kernarg_size 88
  .amdhsa_user_sgpr_count 2
  .amdhsa_user_sgpr_kernarg_segment_ptr 1
  .amdhsa_system_sgpr_workgroup_id_x 1
.end_amdhsa_kernel

.p2align 6
.amdhsa_kernel oproj_kernel
  .amdhsa_next_free_vgpr 120
  .amdhsa_next_free_sgpr 96
  .amdhsa_accum_offset 120
  .amdhsa_group_segment_fixed_size 0
  .amdhsa_kernarg_size 88
  .amdhsa_user_sgpr_count 2
  .amdhsa_user_sgpr_kernarg_segment_ptr 1
  .amdhsa_system_sgpr_workgroup_id_x 1
.end_amdhsa_kernel

.p2align 6
.amdhsa_kernel ln_kernel
  .amdhsa_next_free_vgpr 24
  .amdhsa_next_free_sgpr 96
  .amdhsa_accum_offset 24
  .amdhsa_group_segment_fixed_size 0
  .amdhsa_kernarg_size 88
  .amdhsa_user_sgpr_count 2
  .amdhsa_user_sgpr_kernarg_segment_ptr 1
  .amdhsa_system_sgpr_workgroup_id_x 1
.end_amdhsa_kernel

.p2align 6
.amdhsa_kernel mlp1_kernel
  .amdhsa_next_free_vgpr 168
  .amdhsa_next_free_sgpr 96
  .amdhsa_accum_offset 168
  .amdhsa_group_segment_fixed_size 0
  .amdhsa_kernarg_size 88
  .amdhsa_user_sgpr_count 2
  .amdhsa_user_sgpr_kernarg_segment_ptr 1
  .amdhsa_system_sgpr_workgroup_id_x 1
.end_amdhsa_kernel

.p2align 6
.amdhsa_kernel mlp2_kernel
  .amdhsa_next_free_vgpr 208
  .amdhsa_next_free_sgpr 96
  .amdhsa_accum_offset 208
  .amdhsa_group_segment_fixed_size 0
  .amdhsa_kernarg_size 88
  .amdhsa_user_sgpr_count 2
  .amdhsa_user_sgpr_kernarg_segment_ptr 1
  .amdhsa_system_sgpr_workgroup_id_x 1
.end_amdhsa_kernel

.p2align 6
.amdhsa_kernel final_kernel
  .amdhsa_next_free_vgpr 48
  .amdhsa_next_free_sgpr 96
  .amdhsa_accum_offset 48
  .amdhsa_group_segment_fixed_size 0
  .amdhsa_kernarg_size 88
  .amdhsa_user_sgpr_count 2
  .amdhsa_user_sgpr_kernarg_segment_ptr 1
  .amdhsa_system_sgpr_workgroup_id_x 1
.end_amdhsa_kernel
```
